```python
import torch

def _softmax(x, axis=-1):
    return torch.softmax(x, dim=axis)
def _gelu(x):
    return torch.nn.functional.gelu(x, approximate="tanh")
def _silu(x):
    return torch.nn.functional.silu(x)
def _sigmoid(x):
    return torch.sigmoid(x)
def _layernorm(x, axis=-1, eps=1e-5):
    m = x.mean(dim=axis, keepdim=True)
    v = x.var(dim=axis, keepdim=True, unbiased=False)
    return (x - m) / torch.sqrt(v + eps)
def _scatter_add(tgt, idx, src, axis=0):
    return tgt.clone().index_add_(axis, idx, src)
def _segment_sum(src, seg, n):
    out = torch.zeros((n,) + src.shape[1:], dtype=src.dtype)
    return out.index_add_(0, seg, src)
def _pad(x, pw):
    flat = tuple(v for pair in reversed(pw) for v in pair)
    return torch.nn.functional.pad(x, flat)

kernel_name = 'sequential_preLN__spectral_gfnet__moe_arch_mod__prompt'

def setup_inputs():

    _w = (lambda a: (lambda t: t.to(torch.bfloat16) if t.is_floating_point() else t)(torch.as_tensor(a)))
    def _A_setup():
        B, S, D = 1, 2048, 576
        Df = D // 2 + 1
        return {
            "x": _w((lambda *s: torch.randn(*s, dtype=torch.bfloat16) * 0.05)(B, S, D)),
            "w_r": _w((lambda *s: torch.randn(*s, dtype=torch.bfloat16) * 0.4)(S, Df) * 0.02),
            "w_i": _w((lambda *s: torch.randn(*s, dtype=torch.bfloat16) * 0.4)(S, Df) * 0.02),
        }
    _A_in = _A_setup()

    def _B_setup():
        B, S, D, F, C = 1, 2048, 576, 4608, 2
        return {
            "x": _w((lambda *s: torch.randn(*s, dtype=torch.bfloat16) * 0.05)(B, S, D)),
            "w_r": _w((lambda *s: torch.randn(*s, dtype=torch.bfloat16) * 0.05)(D)),
            "w_gate": _w((lambda *s: torch.randn(*s, dtype=torch.bfloat16) * 0.05)(D, F)),
            "w_up": _w((lambda *s: torch.randn(*s, dtype=torch.bfloat16) * 0.05)(D, F)),
            "w_down": _w((lambda *s: torch.randn(*s, dtype=torch.bfloat16) * 0.05)(F, D)),
        }
    _B_in = _B_setup()

    return {
        "A_x": _A_in["x"],
        "A_w_r": _A_in["w_r"],
        "A_w_i": _A_in["w_i"],
        "B_x": _B_in["x"],
        "B_w_r": _B_in["w_r"],
        "B_w_gate": _B_in["w_gate"],
        "B_w_up": _B_in["w_up"],
        "B_w_down": _B_in["w_down"],
    }

def reference(A_x, A_w_r, A_w_i, B_x, B_w_r, B_w_gate, B_w_up, B_w_down):
    def _A_ref(x, w_r, w_i):
        B, S, D = x.shape
        X = (lambda x, axes=(-2,-1): torch.fft.rfft2(x.float(), dim=axes))(x, axes=(-2, -1))
        W = w_r + 1j * w_i
        X = X * W
        y = (lambda x, s, axes=(-2,-1): torch.fft.irfft2(x, s=s, dim=axes).to(torch.bfloat16))(X, (S, D), axes=(-2, -1))
        return y

    def _B_ref(x, w_r, w_gate, w_up, w_down):
        B, S, D = x.shape
        C = 2
        r = x @ w_r
        idx = torch.argsort(-r, axis=-1)[:, :C]
        idx_e = (lambda x, n, axis: torch.repeat_interleave(x, n, dim=axis))(idx.reshape(B, C, 1), D, axis=2)
        x_sel = (lambda x, i, axis: torch.take_along_dim(x, i, dim=axis))(x, idx_e, axis=1)
        g = _silu(x_sel @ w_gate)
        u = x_sel @ w_up
        y = (g * u) @ w_down
        r_sel = _sigmoid((lambda x, i, axis: torch.take_along_dim(x, i, dim=axis))(r, idx, axis=1))
        y = y * r_sel.reshape(B, C, 1)
        b_off = (torch.arange(B) * S).reshape(B, 1)
        flat_idx = (idx + b_off).reshape(B * C)
        zero = (x * 0.0).reshape(B * S, D)
        upd = _scatter_add(zero, flat_idx, y.reshape(B * C, D), axis=0)
        return x + upd.reshape(B, S, D)

    x = A_x
    h = x + _A_ref(_layernorm(x, axis=-1), A_w_r, A_w_i)
    h2 = h + _B_ref(_layernorm(h, axis=-1), B_w_r, B_w_gate, B_w_up, B_w_down)
    return h2
```

```asm
; @launch kernel=fft_rows_kernel grid=(728,1,1) block=(256,1,1) lds=26112
; @launch kernel=fft_cols_kernel grid=(505,1,1) block=(256,1,1) lds=8192
; @launch kernel=ifft_rows_kernel grid=(472,1,1) block=(256,1,1) lds=20608
; @launch kernel=moe_ffn_kernel grid=(288,1,1) block=(384,1,1) lds=56832
; @launch kernel=moe_fin_kernel grid=(36,1,1) block=(256,1,1) lds=1024
.amdgcn_target "amdgcn-amd-amdhsa--gfx950"
.text
.globl fft_rows_kernel
.p2align 8
.type fft_rows_kernel,@function
fft_rows_kernel:
    s_load_dwordx2 s[4:5], s[0:1], 0
    s_load_dwordx4 s[8:11], s[0:1], 8
    s_load_dwordx2 s[6:7], s[0:1], 80
    v_and_b32 v1, 63, v0
    v_lshrrev_b32 v3, 6, v0
    s_cmp_ge_u32 s2, 512
    s_cbranch_scc1 K1_SIDE
    v_readfirstlane_b32 s3, v3
    s_cmp_ge_u32 s2, 256
    s_cbranch_scc1 K1_W
    v_lshrrev_b32 v13, 4, v1
    v_and_b32 v14, 15, v1
    v_cvt_f32_u32 v15, v14
    v_cvt_f32_u32 v16, v13
    v_mul_f32 v17, v15, v16
    v_mul_f32 v18, 0x3ee38e39, v17
    v_fmamk_f32 v56, v15, 0x00000000, v18
    v_fmamk_f32 v57, v15, 0x3d638e39, v18
    v_fmamk_f32 v58, v15, 0x3de38e39, v18
    v_fmamk_f32 v59, v15, 0x3e2aaaab, v18
    v_fmamk_f32 v60, v15, 0x3e638e39, v18
    v_fmamk_f32 v61, v15, 0x3e8e38e4, v18
    v_fmamk_f32 v62, v15, 0x3eaaaaab, v18
    v_fmamk_f32 v63, v15, 0x3ec71c72, v18
    v_cos_f32 v64, v56
    v_cos_f32 v65, v57
    v_cos_f32 v66, v58
    v_cos_f32 v67, v59
    v_cos_f32 v68, v60
    v_cos_f32 v69, v61
    v_cos_f32 v70, v62
    v_cos_f32 v71, v63
    v_sin_f32 v72, v56
    v_sin_f32 v73, v57
    v_sin_f32 v74, v58
    v_sin_f32 v75, v59
    v_sin_f32 v76, v60
    v_sin_f32 v77, v61
    v_sin_f32 v78, v62
    v_sin_f32 v79, v63
    v_cvt_pk_f16_f32 v20, v64, v65
    v_cvt_pk_f16_f32 v21, v66, v67
    v_cvt_pk_f16_f32 v22, v68, v69
    v_cvt_pk_f16_f32 v23, v70, v71
    v_cvt_pk_f16_f32 v28, v72, v73
    v_cvt_pk_f16_f32 v29, v74, v75
    v_cvt_pk_f16_f32 v30, v76, v77
    v_cvt_pk_f16_f32 v31, v78, v79
    v_xor_b32 v24, 0x80008000, v28
    v_xor_b32 v25, 0x80008000, v29
    v_xor_b32 v26, 0x80008000, v30
    v_xor_b32 v27, 0x80008000, v31
    s_lshr_b32 s28, s2, 3
    s_and_b32 s29, s2, 1
    s_bfe_u32 s30, s2, 0x20001
    s_lshl_b32 s31, s29, 5
    s_lshr_b32 s32, s3, 1
    s_lshl_b32 s33, s32, 4
    s_add_u32 s31, s31, s33
    s_lshl_b32 s33, s30, 2
    s_add_u32 s31, s31, s33
    s_and_b32 s33, s3, 1
    s_lshl_b32 s34, s33, 1
    s_add_u32 s31, s31, s34
    s_lshl_b32 s31, s31, 5
    s_add_u32 s31, s31, s28
    s_mul_i32 s31, s31, 1152
    v_lshrrev_b32 v3, 5, v1
    v_mul_u32_u24 v2, 36864, v3
    v_and_b32 v3, 31, v1
    v_lshl_add_u32 v18, v3, 2, v2
    v_lshl_add_u32 v2, v3, 4, v2
    s_waitcnt lgkmcnt(0)
    s_mov_b32 s12, s4
    s_and_b32 s13, s5, 0xffff
    s_mov_b32 s14, 0x240000
    s_mov_b32 s15, 0x00020000
    buffer_load_dwordx4 v[4:7], v2, s[12:15], s31 offen
    buffer_load_dwordx4 v[8:11], v2, s[12:15], s31 offen offset:512
    buffer_load_dword v12, v18, s[12:15], s31 offen offset:1024
    s_mov_b32 s16, s6
    s_and_b32 s17, s7, 0xffff
    s_mov_b32 s18, 0x2000000
    s_mov_b32 s19, 0x00020000
    s_mov_b32 exec_lo, 0x0
    s_mov_b32 exec_hi, 0xffffffff
    v_mov_b32 v21, 0
    v_mov_b32 v22, 0
    v_mov_b32 v23, 0
    v_mov_b32 v25, 0
    v_mov_b32 v26, 0
    v_mov_b32 v27, 0
    s_mov_b32 exec_lo, 0x0
    s_mov_b32 exec_hi, 0xffff0000
    v_mov_b32 v20, 0
    v_mov_b32 v24, 0
    s_mov_b64 exec, -1
    v_mul_f32 v18, 0x3be38e39, v17
    v_fmamk_f32 v56, v15, 0x00000000, v18
    v_fmamk_f32 v57, v15, 0x3ae38e39, v18
    v_fmamk_f32 v58, v15, 0x3b638e39, v18
    v_fmamk_f32 v59, v15, 0x3baaaaab, v18
    v_fmamk_f32 v60, v15, 0x3ce38e39, v18
    v_fmamk_f32 v61, v15, 0x3cf1c71c, v18
    v_fmamk_f32 v62, v15, 0x3d000000, v18
    v_fmamk_f32 v63, v15, 0x3d071c72, v18
    v_cos_f32 v32, v56
    v_cos_f32 v33, v57
    v_cos_f32 v34, v58
    v_cos_f32 v35, v59
    v_cos_f32 v36, v60
    v_cos_f32 v37, v61
    v_cos_f32 v38, v62
    v_cos_f32 v39, v63
    v_sin_f32 v40, v56
    v_sin_f32 v41, v57
    v_sin_f32 v42, v58
    v_sin_f32 v43, v59
    v_sin_f32 v44, v60
    v_sin_f32 v45, v61
    v_sin_f32 v46, v62
    v_sin_f32 v47, v63
    s_lshl_b32 s34, s33, 4
    v_add_u32 v18, s34, v14
    v_cvt_f32_u32 v18, v18
    v_mul_f32 v19, v18, v16
    v_mul_f32 v19, 0x3e800000, v19
    v_mul_f32 v32, 0x3d2aaaab, v32
    v_mul_f32 v33, 0x3d2aaaab, v33
    v_mul_f32 v34, 0x3d2aaaab, v34
    v_mul_f32 v35, 0x3d2aaaab, v35
    v_mul_f32 v36, 0x3d2aaaab, v36
    v_mul_f32 v37, 0x3d2aaaab, v37
    v_mul_f32 v38, 0x3d2aaaab, v38
    v_mul_f32 v39, 0x3d2aaaab, v39
    v_mul_f32 v40, 0x3d2aaaab, v40
    v_mul_f32 v41, 0x3d2aaaab, v41
    v_mul_f32 v42, 0x3d2aaaab, v42
    v_mul_f32 v43, 0x3d2aaaab, v43
    v_mul_f32 v44, 0x3d2aaaab, v44
    v_mul_f32 v45, 0x3d2aaaab, v45
    v_mul_f32 v46, 0x3d2aaaab, v46
    v_mul_f32 v47, 0x3d2aaaab, v47
    v_fmamk_f32 v56, v18, 0x00000000, v19
    v_fmamk_f32 v57, v18, 0x3d000000, v19
    v_fmamk_f32 v58, v18, 0x3d800000, v19
    v_fmamk_f32 v59, v18, 0x3dc00000, v19
    v_fmamk_f32 v60, v18, 0x3e000000, v19
    v_fmamk_f32 v61, v18, 0x3e200000, v19
    v_fmamk_f32 v62, v18, 0x3e400000, v19
    v_fmamk_f32 v63, v18, 0x3e600000, v19
    v_cos_f32 v64, v56
    v_cos_f32 v65, v57
    v_cos_f32 v66, v58
    v_cos_f32 v67, v59
    v_cos_f32 v68, v60
    v_cos_f32 v69, v61
    v_cos_f32 v70, v62
    v_cos_f32 v71, v63
    v_sin_f32 v72, v56
    v_sin_f32 v73, v57
    v_sin_f32 v74, v58
    v_sin_f32 v75, v59
    v_sin_f32 v76, v60
    v_sin_f32 v77, v61
    v_sin_f32 v78, v62
    v_sin_f32 v79, v63
    v_cvt_pk_f16_f32 v48, v64, v65
    v_cvt_pk_f16_f32 v49, v66, v67
    v_cvt_pk_f16_f32 v50, v68, v69
    v_cvt_pk_f16_f32 v51, v70, v71
    v_cvt_pk_f16_f32 v52, v72, v73
    v_cvt_pk_f16_f32 v53, v74, v75
    v_cvt_pk_f16_f32 v54, v76, v77
    v_cvt_pk_f16_f32 v55, v78, v79
    s_mul_i32 s35, s32, 0x80008000
    v_xor_b32 v52, s35, v52
    v_xor_b32 v53, s35, v53
    v_xor_b32 v54, s35, v54
    v_xor_b32 v55, s35, v55
    v_lshrrev_b32 v3, 5, v1
    v_mul_u32_u24 v18, 1152, v3
    v_and_b32 v3, 31, v1
    s_mul_i32 s36, s3, 2304
    v_add_u32 v18, s36, v18
    v_lshl_add_u32 v118, v3, 2, v18
    v_lshl_add_u32 v18, v3, 4, v18
    v_bfe_u32 v3, v1, 2, 2
    v_lshl_add_u32 v3, v13, 3, v3
    v_min_u32 v19, 17, v3
    v_add_u32 v3, 4, v3
    v_min_u32 v3, 17, v3
    v_and_b32 v116, 3, v1
    v_lshlrev_b32 v116, 3, v116
    v_add_u32 v116, s36, v116
    v_lshl_add_u32 v117, v3, 6, v116
    v_lshl_add_u32 v116, v19, 6, v116
    s_waitcnt vmcnt(0)
    v_lshlrev_b32 v80, 16, v4
    v_and_b32 v81, 0xffff0000, v4
    v_lshlrev_b32 v82, 16, v5
    v_and_b32 v83, 0xffff0000, v5
    v_lshlrev_b32 v84, 16, v6
    v_and_b32 v85, 0xffff0000, v6
    v_lshlrev_b32 v86, 16, v7
    v_and_b32 v87, 0xffff0000, v7
    v_lshlrev_b32 v88, 16, v8
    v_and_b32 v89, 0xffff0000, v8
    v_lshlrev_b32 v90, 16, v9
    v_and_b32 v91, 0xffff0000, v9
    v_lshlrev_b32 v92, 16, v10
    v_and_b32 v93, 0xffff0000, v10
    v_lshlrev_b32 v94, 16, v11
    v_and_b32 v95, 0xffff0000, v11
    v_lshlrev_b32 v96, 16, v12
    v_and_b32 v97, 0xffff0000, v12
    v_add_f32 v56, v80, v81
    v_add_f32 v56, v56, v82
    v_add_f32 v56, v56, v83
    v_add_f32 v56, v56, v84
    v_add_f32 v56, v56, v85
    v_add_f32 v56, v56, v86
    v_add_f32 v56, v56, v87
    v_add_f32 v56, v56, v88
    v_add_f32 v56, v56, v89
    v_add_f32 v56, v56, v90
    v_add_f32 v56, v56, v91
    v_add_f32 v56, v56, v92
    v_add_f32 v56, v56, v93
    v_add_f32 v56, v56, v94
    v_add_f32 v56, v56, v95
    v_add_f32 v56, v56, v96
    v_add_f32 v56, v56, v97
    s_nop 1
    v_add_f32_dpp v56, v56, v56 quad_perm:[1,0,3,2] row_mask:0xf bank_mask:0xf
    s_nop 1
    v_add_f32_dpp v56, v56, v56 quad_perm:[2,3,0,1] row_mask:0xf bank_mask:0xf
    s_nop 1
    v_add_f32_dpp v56, v56, v56 row_half_mirror row_mask:0xf bank_mask:0xf
    s_nop 1
    v_add_f32_dpp v56, v56, v56 row_mirror row_mask:0xf bank_mask:0xf
    v_mov_b32 v57, v56
    s_nop 1
    v_permlane16_swap_b32 v56, v57
    v_add_f32 v56, v56, v57
    v_mul_f32 v56, 0x3ae38e39, v56
    v_sub_f32 v59, v80, v56
    v_mul_f32 v58, v59, v59
    v_sub_f32 v60, v81, v56
    v_fmac_f32 v58, v60, v60
    v_sub_f32 v59, v82, v56
    v_fmac_f32 v58, v59, v59
    v_sub_f32 v60, v83, v56
    v_fmac_f32 v58, v60, v60
    v_sub_f32 v59, v84, v56
    v_fmac_f32 v58, v59, v59
    v_sub_f32 v60, v85, v56
    v_fmac_f32 v58, v60, v60
    v_sub_f32 v59, v86, v56
    v_fmac_f32 v58, v59, v59
    v_sub_f32 v60, v87, v56
    v_fmac_f32 v58, v60, v60
    v_sub_f32 v59, v88, v56
    v_fmac_f32 v58, v59, v59
    v_sub_f32 v60, v89, v56
    v_fmac_f32 v58, v60, v60
    v_sub_f32 v59, v90, v56
    v_fmac_f32 v58, v59, v59
    v_sub_f32 v60, v91, v56
    v_fmac_f32 v58, v60, v60
    v_sub_f32 v59, v92, v56
    v_fmac_f32 v58, v59, v59
    v_sub_f32 v60, v93, v56
    v_fmac_f32 v58, v60, v60
    v_sub_f32 v59, v94, v56
    v_fmac_f32 v58, v59, v59
    v_sub_f32 v60, v95, v56
    v_fmac_f32 v58, v60, v60
    v_sub_f32 v59, v96, v56
    v_fmac_f32 v58, v59, v59
    v_sub_f32 v60, v97, v56
    v_fmac_f32 v58, v60, v60
    s_nop 1
    v_add_f32_dpp v58, v58, v58 quad_perm:[1,0,3,2] row_mask:0xf bank_mask:0xf
    s_nop 1
    v_add_f32_dpp v58, v58, v58 quad_perm:[2,3,0,1] row_mask:0xf bank_mask:0xf
    s_nop 1
    v_add_f32_dpp v58, v58, v58 row_half_mirror row_mask:0xf bank_mask:0xf
    s_nop 1
    v_add_f32_dpp v58, v58, v58 row_mirror row_mask:0xf bank_mask:0xf
    v_mov_b32 v57, v58
    s_nop 1
    v_permlane16_swap_b32 v58, v57
    v_add_f32 v58, v58, v57
    v_mul_f32 v58, 0x3ae38e39, v58
    v_cvt_pk_bf16_f32 v57, v56, v56
    v_lshlrev_b32 v56, 16, v57
    v_cvt_pk_bf16_f32 v57, v58, v58
    v_lshlrev_b32 v58, 16, v57
    v_add_f32 v58, 0x3727c5ac, v58
    v_cvt_pk_bf16_f32 v57, v58, v58
    v_lshlrev_b32 v58, 16, v57
    v_sqrt_f32 v58, v58
    s_nop 0
    v_cvt_pk_bf16_f32 v57, v58, v58
    v_lshlrev_b32 v58, 16, v57
    v_rcp_f32 v59, v58
    v_sub_f32 v80, v80, v56
    v_sub_f32 v81, v81, v56
    v_cvt_pk_bf16_f32 v100, v80, v81
    v_sub_f32 v82, v82, v56
    v_sub_f32 v83, v83, v56
    v_cvt_pk_bf16_f32 v101, v82, v83
    v_sub_f32 v84, v84, v56
    v_sub_f32 v85, v85, v56
    v_cvt_pk_bf16_f32 v102, v84, v85
    v_sub_f32 v86, v86, v56
    v_sub_f32 v87, v87, v56
    v_cvt_pk_bf16_f32 v103, v86, v87
    v_sub_f32 v88, v88, v56
    v_sub_f32 v89, v89, v56
    v_cvt_pk_bf16_f32 v104, v88, v89
    v_sub_f32 v90, v90, v56
    v_sub_f32 v91, v91, v56
    v_cvt_pk_bf16_f32 v105, v90, v91
    v_sub_f32 v92, v92, v56
    v_sub_f32 v93, v93, v56
    v_cvt_pk_bf16_f32 v106, v92, v93
    v_sub_f32 v94, v94, v56
    v_sub_f32 v95, v95, v56
    v_cvt_pk_bf16_f32 v107, v94, v95
    v_sub_f32 v96, v96, v56
    v_sub_f32 v97, v97, v56
    v_cvt_pk_bf16_f32 v108, v96, v97
    v_lshlrev_b32 v80, 16, v100
    v_and_b32 v81, 0xffff0000, v100
    v_lshlrev_b32 v82, 16, v101
    v_and_b32 v83, 0xffff0000, v101
    v_lshlrev_b32 v84, 16, v102
    v_and_b32 v85, 0xffff0000, v102
    v_lshlrev_b32 v86, 16, v103
    v_and_b32 v87, 0xffff0000, v103
    v_lshlrev_b32 v88, 16, v104
    v_and_b32 v89, 0xffff0000, v104
    v_lshlrev_b32 v90, 16, v105
    v_and_b32 v91, 0xffff0000, v105
    v_lshlrev_b32 v92, 16, v106
    v_and_b32 v93, 0xffff0000, v106
    v_lshlrev_b32 v94, 16, v107
    v_and_b32 v95, 0xffff0000, v107
    v_lshlrev_b32 v96, 16, v108
    v_and_b32 v97, 0xffff0000, v108
    v_mul_f32 v60, v80, v59
    v_fma_f32 v61, -v60, v58, v80
    v_fma_f32 v80, v61, v59, v60
    v_mul_f32 v62, v81, v59
    v_fma_f32 v63, -v62, v58, v81
    v_fma_f32 v81, v63, v59, v62
    v_mul_f32 v60, v82, v59
    v_fma_f32 v61, -v60, v58, v82
    v_fma_f32 v82, v61, v59, v60
    v_mul_f32 v62, v83, v59
    v_fma_f32 v63, -v62, v58, v83
    v_fma_f32 v83, v63, v59, v62
    v_mul_f32 v60, v84, v59
    v_fma_f32 v61, -v60, v58, v84
    v_fma_f32 v84, v61, v59, v60
    v_mul_f32 v62, v85, v59
    v_fma_f32 v63, -v62, v58, v85
    v_fma_f32 v85, v63, v59, v62
    v_mul_f32 v60, v86, v59
    v_fma_f32 v61, -v60, v58, v86
    v_fma_f32 v86, v61, v59, v60
    v_mul_f32 v62, v87, v59
    v_fma_f32 v63, -v62, v58, v87
    v_fma_f32 v87, v63, v59, v62
    v_mul_f32 v60, v88, v59
    v_fma_f32 v61, -v60, v58, v88
    v_fma_f32 v88, v61, v59, v60
    v_mul_f32 v62, v89, v59
    v_fma_f32 v63, -v62, v58, v89
    v_fma_f32 v89, v63, v59, v62
    v_mul_f32 v60, v90, v59
    v_fma_f32 v61, -v60, v58, v90
    v_fma_f32 v90, v61, v59, v60
    v_mul_f32 v62, v91, v59
    v_fma_f32 v63, -v62, v58, v91
    v_fma_f32 v91, v63, v59, v62
    v_mul_f32 v60, v92, v59
    v_fma_f32 v61, -v60, v58, v92
    v_fma_f32 v92, v61, v59, v60
    v_mul_f32 v62, v93, v59
    v_fma_f32 v63, -v62, v58, v93
    v_fma_f32 v93, v63, v59, v62
    v_mul_f32 v60, v94, v59
    v_fma_f32 v61, -v60, v58, v94
    v_fma_f32 v94, v61, v59, v60
    v_mul_f32 v62, v95, v59
    v_fma_f32 v63, -v62, v58, v95
    v_fma_f32 v95, v63, v59, v62
    v_mul_f32 v60, v96, v59
    v_fma_f32 v61, -v60, v58, v96
    v_fma_f32 v96, v61, v59, v60
    v_mul_f32 v62, v97, v59
    v_fma_f32 v63, -v62, v58, v97
    v_fma_f32 v97, v63, v59, v62
    v_cvt_pk_bf16_f32 v100, v80, v81
    v_cvt_pk_bf16_f32 v101, v82, v83
    v_cvt_pk_bf16_f32 v102, v84, v85
    v_cvt_pk_bf16_f32 v103, v86, v87
    v_cvt_pk_bf16_f32 v104, v88, v89
    v_cvt_pk_bf16_f32 v105, v90, v91
    v_cvt_pk_bf16_f32 v106, v92, v93
    v_cvt_pk_bf16_f32 v107, v94, v95
    v_cvt_pk_bf16_f32 v108, v96, v97
    v_lshlrev_b32 v80, 16, v100
    v_and_b32 v81, 0xffff0000, v100
    v_lshlrev_b32 v82, 16, v101
    v_and_b32 v83, 0xffff0000, v101
    v_lshlrev_b32 v84, 16, v102
    v_and_b32 v85, 0xffff0000, v102
    v_lshlrev_b32 v86, 16, v103
    v_and_b32 v87, 0xffff0000, v103
    v_lshlrev_b32 v88, 16, v104
    v_and_b32 v89, 0xffff0000, v104
    v_lshlrev_b32 v90, 16, v105
    v_and_b32 v91, 0xffff0000, v105
    v_lshlrev_b32 v92, 16, v106
    v_and_b32 v93, 0xffff0000, v106
    v_lshlrev_b32 v94, 16, v107
    v_and_b32 v95, 0xffff0000, v107
    v_lshlrev_b32 v96, 16, v108
    v_and_b32 v97, 0xffff0000, v108
    v_cvt_pkrtz_f16_f32 v100, v80, v81
    v_cvt_pkrtz_f16_f32 v101, v82, v83
    v_cvt_pkrtz_f16_f32 v102, v84, v85
    v_cvt_pkrtz_f16_f32 v103, v86, v87
    v_cvt_pkrtz_f16_f32 v104, v88, v89
    v_cvt_pkrtz_f16_f32 v105, v90, v91
    v_cvt_pkrtz_f16_f32 v106, v92, v93
    v_cvt_pkrtz_f16_f32 v107, v94, v95
    v_cvt_pkrtz_f16_f32 v108, v96, v97
    ds_write_b128 v18, v[100:103]
    ds_write_b128 v18, v[104:107] offset:512
    ds_write_b32 v118, v108 offset:1024
    ds_read_b64_tr_b16 v[56:57], v116 offset:0
    ds_read_b64_tr_b16 v[58:59], v117 offset:0
    ds_read_b64_tr_b16 v[60:61], v116 offset:32
    ds_read_b64_tr_b16 v[62:63], v117 offset:32
    ds_read_b64_tr_b16 v[80:81], v116 offset:1152
    ds_read_b64_tr_b16 v[82:83], v117 offset:1152
    ds_read_b64_tr_b16 v[84:85], v116 offset:1184
    ds_read_b64_tr_b16 v[86:87], v117 offset:1184
    v_mul_u32_u24 v18, 528, v14
    v_lshl_add_u32 v18, v13, 3, v18
    s_lshl_b32 s36, s3, 7
    s_add_u32 s36, s36, 9216
    v_add_u32 v18, s36, v18
    v_lshrrev_b32 v3, 2, v14
    v_mul_u32_u24 v19, 528, v3
    v_and_b32 v3, 3, v14
    v_lshl_add_u32 v19, v3, 6, v19
    v_lshl_add_u32 v19, v13, 4, v19
    s_mul_i32 s36, s32, 8448
    s_add_u32 s37, s36, 9216
    s_sub_u32 s36, 17664, s36
    v_lshl_add_u32 v2, v13, 5, v14
    v_add_u32 v2, s34, v2
    v_lshlrev_b32 v2, 13, v2
    s_waitcnt lgkmcnt(4)
    v_mfma_f32_16x16x32_f16 v[64:67], v[56:59], v[20:23], 0
    v_mfma_f32_16x16x32_f16 v[72:75], v[56:59], v[24:27], 0
    v_mfma_f32_16x16x32_f16 v[68:71], v[60:63], v[20:23], 0
    v_mfma_f32_16x16x32_f16 v[76:79], v[60:63], v[24:27], 0
    s_waitcnt lgkmcnt(0)
    v_mfma_f32_16x16x32_f16 v[88:91], v[80:83], v[20:23], 0
    v_mfma_f32_16x16x32_f16 v[96:99], v[80:83], v[24:27], 0
    v_mfma_f32_16x16x32_f16 v[92:95], v[84:87], v[20:23], 0
    v_mfma_f32_16x16x32_f16 v[100:103], v[84:87], v[24:27], 0
    v_add_u32 v16, s37, v19
    v_add_u32 v17, s36, v19
    s_nop 4
    v_mul_f32 v120, v64, v32
    v_mul_f32 v124, v72, v32
    v_fmac_f32 v120, v72, v40
    v_fma_f32 v124, -v64, v40, v124
    v_mul_f32 v121, v65, v33
    v_mul_f32 v125, v73, v33
    v_fmac_f32 v121, v73, v41
    v_fma_f32 v125, -v65, v41, v125
    v_mul_f32 v122, v66, v34
    v_mul_f32 v126, v74, v34
    v_fmac_f32 v122, v74, v42
    v_fma_f32 v126, -v66, v42, v126
    v_mul_f32 v123, v67, v35
    v_mul_f32 v127, v75, v35
    v_fmac_f32 v123, v75, v43
    v_fma_f32 v127, -v67, v43, v127
    v_cvt_pk_f16_f32 v104, v120, v121
    v_cvt_pk_f16_f32 v105, v122, v123
    v_cvt_pk_f16_f32 v106, v124, v125
    v_cvt_pk_f16_f32 v107, v126, v127
    ds_write_b64 v18, v[104:105] offset:0
    ds_write_b64 v18, v[106:107] offset:8448
    v_mul_f32 v120, v68, v36
    v_mul_f32 v124, v76, v36
    v_fmac_f32 v120, v76, v44
    v_fma_f32 v124, -v68, v44, v124
    v_mul_f32 v121, v69, v37
    v_mul_f32 v125, v77, v37
    v_fmac_f32 v121, v77, v45
    v_fma_f32 v125, -v69, v45, v125
    v_mul_f32 v122, v70, v38
    v_mul_f32 v126, v78, v38
    v_fmac_f32 v122, v78, v46
    v_fma_f32 v126, -v70, v46, v126
    v_mul_f32 v123, v71, v39
    v_mul_f32 v127, v79, v39
    v_fmac_f32 v123, v79, v47
    v_fma_f32 v127, -v71, v47, v127
    v_cvt_pk_f16_f32 v108, v120, v121
    v_cvt_pk_f16_f32 v109, v122, v123
    v_cvt_pk_f16_f32 v110, v124, v125
    v_cvt_pk_f16_f32 v111, v126, v127
    ds_write_b64 v18, v[108:109] offset:32
    ds_write_b64 v18, v[110:111] offset:8480
    v_mul_f32 v120, v88, v32
    v_mul_f32 v124, v96, v32
    v_fmac_f32 v120, v96, v40
    v_fma_f32 v124, -v88, v40, v124
    v_mul_f32 v121, v89, v33
    v_mul_f32 v125, v97, v33
    v_fmac_f32 v121, v97, v41
    v_fma_f32 v125, -v89, v41, v125
    v_mul_f32 v122, v90, v34
    v_mul_f32 v126, v98, v34
    v_fmac_f32 v122, v98, v42
    v_fma_f32 v126, -v90, v42, v126
    v_mul_f32 v123, v91, v35
    v_mul_f32 v127, v99, v35
    v_fmac_f32 v123, v99, v43
    v_fma_f32 v127, -v91, v43, v127
    v_cvt_pk_f16_f32 v112, v120, v121
    v_cvt_pk_f16_f32 v113, v122, v123
    v_cvt_pk_f16_f32 v114, v124, v125
    v_cvt_pk_f16_f32 v115, v126, v127
    ds_write_b64 v18, v[112:113] offset:64
    ds_write_b64 v18, v[114:115] offset:8512
    v_mul_f32 v120, v92, v36
    v_mul_f32 v124, v100, v36
    v_fmac_f32 v120, v100, v44
    v_fma_f32 v124, -v92, v44, v124
    v_mul_f32 v121, v93, v37
    v_mul_f32 v125, v101, v37
    v_fmac_f32 v121, v101, v45
    v_fma_f32 v125, -v93, v45, v125
    v_mul_f32 v122, v94, v38
    v_mul_f32 v126, v102, v38
    v_fmac_f32 v122, v102, v46
    v_fma_f32 v126, -v94, v46, v126
    v_mul_f32 v123, v95, v39
    v_mul_f32 v127, v103, v39
    v_fmac_f32 v123, v103, v47
    v_fma_f32 v127, -v95, v47, v127
    v_cvt_pk_f16_f32 v116, v120, v121
    v_cvt_pk_f16_f32 v117, v122, v123
    v_cvt_pk_f16_f32 v118, v124, v125
    v_cvt_pk_f16_f32 v119, v126, v127
    ds_write_b64 v18, v[116:117] offset:96
    ds_write_b64 v18, v[118:119] offset:8544
    s_lshl_b32 s38, s32, 12
    s_lshl_b32 s39, s29, 11
    s_add_u32 s38, s38, s39
    s_lshr_b32 s39, s28, 4
    s_lshl_b32 s39, s39, 10
    s_add_u32 s38, s38, s39
    s_lshl_b32 s39, s30, 8
    s_add_u32 s38, s38, s39
    s_and_b32 s39, s28, 15
    s_lshl_b32 s39, s39, 4
    s_add_u32 s38, s38, s39
    s_add_u32 s39, s38, 0x100000
    s_add_u32 s40, s38, 0x200000
    s_waitcnt lgkmcnt(0)
    s_barrier
    ds_read_b128 v[56:59], v16 offset:0
    ds_read_b128 v[60:63], v17 offset:0
    ds_read_b128 v[64:67], v16 offset:256
    ds_read_b128 v[68:71], v17 offset:256
    ds_read_b128 v[72:75], v16 offset:2112
    ds_read_b128 v[76:79], v17 offset:2112
    ds_read_b128 v[80:83], v16 offset:2368
    ds_read_b128 v[84:87], v17 offset:2368
    ds_read_b128 v[88:91], v16 offset:4224
    ds_read_b128 v[92:95], v17 offset:4224
    ds_read_b128 v[96:99], v16 offset:4480
    ds_read_b128 v[100:103], v17 offset:4480
    s_waitcnt lgkmcnt(10)
    v_mfma_f32_16x16x32_f16 v[104:107], v[56:59], v[48:51], 0
    v_mfma_f32_16x16x32_f16 v[104:107], v[60:63], v[52:55], v[104:107]
    s_waitcnt lgkmcnt(8)
    v_mfma_f32_16x16x32_f16 v[108:111], v[64:67], v[48:51], 0
    v_mfma_f32_16x16x32_f16 v[108:111], v[68:71], v[52:55], v[108:111]
    s_waitcnt lgkmcnt(6)
    v_mfma_f32_16x16x32_f16 v[112:115], v[72:75], v[48:51], 0
    v_mfma_f32_16x16x32_f16 v[112:115], v[76:79], v[52:55], v[112:115]
    s_waitcnt lgkmcnt(4)
    v_mfma_f32_16x16x32_f16 v[116:119], v[80:83], v[48:51], 0
    v_mfma_f32_16x16x32_f16 v[116:119], v[84:87], v[52:55], v[116:119]
    s_waitcnt lgkmcnt(2)
    v_mfma_f32_16x16x32_f16 v[120:123], v[88:91], v[48:51], 0
    v_mfma_f32_16x16x32_f16 v[120:123], v[92:95], v[52:55], v[120:123]
    s_waitcnt lgkmcnt(0)
    v_mfma_f32_16x16x32_f16 v[124:127], v[96:99], v[48:51], 0
    v_mfma_f32_16x16x32_f16 v[124:127], v[100:103], v[52:55], v[124:127]
    s_nop 7
    v_cvt_pk_f16_f32 v56, v104, v105
    v_cvt_pk_f16_f32 v57, v106, v107
    v_cvt_pk_f16_f32 v58, v108, v109
    v_cvt_pk_f16_f32 v59, v110, v111
    buffer_store_dwordx4 v[56:59], v2, s[16:19], s38 offen
    v_cvt_pk_f16_f32 v60, v112, v113
    v_cvt_pk_f16_f32 v61, v114, v115
    v_cvt_pk_f16_f32 v62, v116, v117
    v_cvt_pk_f16_f32 v63, v118, v119
    buffer_store_dwordx4 v[60:63], v2, s[16:19], s39 offen
    v_cvt_pk_f16_f32 v64, v120, v121
    v_cvt_pk_f16_f32 v65, v122, v123
    v_cvt_pk_f16_f32 v66, v124, v125
    v_cvt_pk_f16_f32 v67, v126, v127
    s_mov_b32 exec_lo, 0xffffffff
    s_mov_b32 exec_hi, 0x0
    buffer_store_dwordx4 v[64:67], v2, s[16:19], s40 offen
    s_endpgm
K1_W:
    s_waitcnt lgkmcnt(0)
    s_mov_b32 s16, s6
    s_and_b32 s17, s7, 0xffff
    s_mov_b32 s18, 0x2000000
    s_mov_b32 s19, 0x00020000
    s_mov_b32 s20, s8
    s_and_b32 s21, s9, 0xffff
    s_mov_b32 s22, 0x121000
    s_mov_b32 s23, 0x00020000
    s_mov_b32 s24, s10
    s_and_b32 s25, s11, 0xffff
    s_mov_b32 s26, 0x121000
    s_mov_b32 s27, 0x00020000
    s_sub_u32 s28, s2, 256
    s_and_b32 s29, s28, 7
    s_lshl_b32 s29, s29, 5
    s_lshr_b32 s28, s28, 3
    s_add_u32 s28, s28, s29
    s_mul_i32 s29, s28, 4624
    v_lshlrev_b32 v2, 4, v0
    v_add_u32 v3, 0x1000, v2
    v_mov_b32 v20, 0x7fffffff
    v_cmp_gt_u32 vcc, 33, v0
    s_nop 1
    v_cndmask_b32 v20, v20, v3, vcc
    buffer_load_dwordx4 v[4:7], v2, s[20:23], s29 offen
    buffer_load_dwordx4 v[8:11], v2, s[24:27], s29 offen
    buffer_load_dwordx4 v[12:15], v20, s[20:23], s29 offen
    buffer_load_dwordx4 v[16:19], v20, s[24:27], s29 offen
    v_min_u32 v3, 0x1210, v3
    s_waitcnt vmcnt(0)
    ds_write_b128 v2, v[4:7]
    ds_write_b128 v2, v[8:11] offset:4640
    ds_write_b128 v3, v[12:15]
    ds_write_b128 v3, v[16:19] offset:4640
    v_and_b32 v24, 0x7fff7fff, v4
    v_and_b32 v25, 0x7fff7fff, v5
    v_and_b32 v26, 0x7fff7fff, v6
    v_and_b32 v27, 0x7fff7fff, v7
    v_and_b32 v28, 0x7fff7fff, v8
    v_and_b32 v29, 0x7fff7fff, v9
    v_and_b32 v30, 0x7fff7fff, v10
    v_and_b32 v31, 0x7fff7fff, v11
    v_and_b32 v32, 0x7fff7fff, v12
    v_and_b32 v33, 0x7fff7fff, v13
    v_and_b32 v34, 0x7fff7fff, v14
    v_and_b32 v35, 0x7fff7fff, v15
    v_and_b32 v36, 0x7fff7fff, v16
    v_and_b32 v37, 0x7fff7fff, v17
    v_and_b32 v38, 0x7fff7fff, v18
    v_and_b32 v39, 0x7fff7fff, v19
    v_pk_max_u16 v24, v24, v25
    v_pk_max_u16 v24, v24, v26
    v_pk_max_u16 v24, v24, v27
    v_pk_max_u16 v24, v24, v28
    v_pk_max_u16 v24, v24, v29
    v_pk_max_u16 v24, v24, v30
    v_pk_max_u16 v24, v24, v31
    v_pk_max_u16 v24, v24, v32
    v_pk_max_u16 v24, v24, v33
    v_pk_max_u16 v24, v24, v34
    v_pk_max_u16 v24, v24, v35
    v_pk_max_u16 v24, v24, v36
    v_pk_max_u16 v24, v24, v37
    v_pk_max_u16 v24, v24, v38
    v_pk_max_u16 v24, v24, v39
    v_lshrrev_b32 v25, 16, v24
    v_and_b32 v24, 0xffff, v24
    v_max_u32 v24, v24, v25
    s_nop 1
    v_max_u32_dpp v24, v24, v24 quad_perm:[1,0,3,2] row_mask:0xf bank_mask:0xf
    s_nop 1
    v_max_u32_dpp v24, v24, v24 quad_perm:[2,3,0,1] row_mask:0xf bank_mask:0xf
    s_nop 1
    v_max_u32_dpp v24, v24, v24 row_half_mirror row_mask:0xf bank_mask:0xf
    s_nop 1
    v_max_u32_dpp v24, v24, v24 row_mirror row_mask:0xf bank_mask:0xf
    v_mov_b32 v25, v24
    s_nop 1
    v_permlane16_swap_b32 v24, v25
    v_max_u32 v24, v24, v25
    v_mov_b32 v25, v24
    s_nop 1
    v_permlane32_swap_b32 v24, v25
    v_max_u32 v24, v24, v25
    s_lshl_b32 s30, s3, 2
    s_add_u32 s30, s30, 9296
    v_mov_b32 v25, s30
    ds_write_b32 v25, v24
    v_and_b32 v21, 1, v0
    v_mul_u32_u24 v22, 2312, v21
    v_and_b32 v23, 0xfe, v0
    v_add_u32 v22, v22, v23
    v_lshlrev_b32 v23, 12, v23
    v_lshl_add_u32 v23, v21, 4, v23
    s_lshl_b32 s31, s28, 5
    s_add_u32 s31, s31, 0x600000
    s_add_u32 s32, s31, 0x100000
    s_add_u32 s33, s31, 0x200000
    s_waitcnt lgkmcnt(0)
    s_barrier
    ds_read_u16 v4, v22 offset:0
    ds_read_u16 v28, v22 offset:4640
    ds_read_u16 v5, v22 offset:578
    ds_read_u16 v29, v22 offset:5218
    ds_read_u16 v6, v22 offset:1156
    ds_read_u16 v30, v22 offset:5796
    ds_read_u16 v7, v22 offset:1734
    ds_read_u16 v31, v22 offset:6374
    ds_read_u16 v8, v22 offset:256
    ds_read_u16 v32, v22 offset:4896
    ds_read_u16 v9, v22 offset:834
    ds_read_u16 v33, v22 offset:5474
    ds_read_u16 v10, v22 offset:1412
    ds_read_u16 v34, v22 offset:6052
    ds_read_u16 v11, v22 offset:1990
    ds_read_u16 v35, v22 offset:6630
    ds_read_u16 v12, v22 offset:512
    ds_read_u16 v36, v22 offset:5152
    ds_read_u16 v13, v22 offset:1090
    ds_read_u16 v37, v22 offset:5730
    ds_read_u16 v14, v22 offset:1668
    ds_read_u16 v38, v22 offset:6308
    ds_read_u16 v15, v22 offset:2246
    ds_read_u16 v39, v22 offset:6886
    v_mov_b32 v25, 9296
    ds_read_b128 v[24:27], v25
    s_waitcnt lgkmcnt(0)
    v_lshl_or_b32 v4, v28, 16, v4
    v_lshl_or_b32 v5, v29, 16, v5
    v_lshl_or_b32 v6, v30, 16, v6
    v_lshl_or_b32 v7, v31, 16, v7
    v_lshl_or_b32 v8, v32, 16, v8
    v_lshl_or_b32 v9, v33, 16, v9
    v_lshl_or_b32 v10, v34, 16, v10
    v_lshl_or_b32 v11, v35, 16, v11
    v_lshl_or_b32 v12, v36, 16, v12
    v_lshl_or_b32 v13, v37, 16, v13
    v_lshl_or_b32 v14, v38, 16, v14
    v_lshl_or_b32 v15, v39, 16, v15
    buffer_store_dwordx4 v[4:7], v23, s[16:19], s31 offen
    buffer_store_dwordx4 v[8:11], v23, s[16:19], s32 offen
    v_cmp_gt_u32 vcc, 66, v0
    s_and_saveexec_b64 s[34:35], vcc
    s_cbranch_execz K1_END
    buffer_store_dwordx4 v[12:15], v23, s[16:19], s33 offen
    s_waitcnt lgkmcnt(0)
    v_max3_u32 v24, v24, v25, v26
    v_max_u32 v24, v24, v27
    s_lshl_b32 s28, s28, 2
    s_add_u32 s28, s28, 0x900000
    v_cmp_eq_u32 vcc, 0, v0
    s_and_saveexec_b64 s[34:35], vcc
    s_cbranch_execz K1_END
    v_mov_b32 v2, 0
    buffer_store_dword v24, v2, s[16:19], s28 offen
    s_endpgm
K1_SIDE:
    s_sub_u32 s28, s2, 512
    s_cmp_ge_u32 s28, 216
    s_cbranch_scc1 K1_END
    s_waitcnt lgkmcnt(0)
    s_load_dwordx4 s[8:11], s[0:1], 40
    s_load_dwordx2 s[4:5], s[0:1], 56
    s_load_dwordx2 s[6:7], s[0:1], 80
    v_readfirstlane_b32 s3, v3
    s_lshl_b32 s28, s28, 2
    s_add_u32 s28, s28, s3
    s_add_u32 s28, s28, 0
    s_mul_i32 s33, s28, 6144
    s_add_u32 s38, s33, 3072
    s_cmp_ge_u32 s28, 864
    s_cselect_b32 s36, 864, 0
    s_cselect_b32 s37, 0x600000, 0
    s_sub_u32 s28, s28, s36
    s_mul_i32 s29, s28, 43691
    s_lshr_b32 s29, s29, 18
    s_mul_i32 s30, s29, 6
    s_sub_u32 s30, s28, s30
    s_mul_i32 s31, s29, 36864
    s_mul_i32 s32, s30, 1536
    s_add_u32 s31, s31, s32
    s_mul_i32 s32, s30, 884736
    s_lshl_b32 s34, s29, 7
    s_add_u32 s32, s32, s34
    s_add_u32 s32, s32, s37
    v_lshrrev_b32 v4, 3, v1
    v_bfe_u32 v5, v1, 1, 2
    v_and_b32 v6, 1, v1
    v_mul_u32_u24 v5, 9216, v5
    v_lshl_add_u32 v5, v4, 5, v5
    v_lshl_add_u32 v5, v6, 4, v5
    v_and_b32 v6, 7, v1
    v_mul_u32_u24 v4, 18432, v4
    v_lshl_add_u32 v4, v6, 4, v4
    v_lshlrev_b32 v6, 4, v1
    s_waitcnt lgkmcnt(0)
    s_mov_b32 s16, s6
    s_and_b32 s17, s7, 0xffff
    s_mov_b32 s18, 0x2000000
    s_mov_b32 s19, 0x00020000
    s_mov_b32 s20, s8
    s_and_b32 s21, s9, 0xffff
    s_mov_b32 s22, 0x510000
    s_mov_b32 s23, 0x00020000
    s_mov_b32 s24, s10
    s_and_b32 s25, s11, 0xffff
    s_mov_b32 s26, 0x510000
    s_mov_b32 s27, 0x00020000
    s_mov_b32 s12, s4
    s_and_b32 s13, s5, 0xffff
    s_mov_b32 s14, 0x510000
    s_mov_b32 s15, 0x00020000
    s_sleep 6
    buffer_load_dwordx4 v[8:11], v6, s[12:15], s33 offen offset:0
    buffer_load_dwordx4 v[12:15], v6, s[12:15], s33 offen offset:1024
    buffer_load_dwordx4 v[16:19], v6, s[12:15], s33 offen offset:2048
    buffer_load_dwordx4 v[20:23], v6, s[12:15], s38 offen offset:0
    buffer_load_dwordx4 v[24:27], v6, s[12:15], s38 offen offset:1024
    buffer_load_dwordx4 v[28:31], v6, s[12:15], s38 offen offset:2048
    s_waitcnt vmcnt(0)
K1_END:
    s_endpgm
.text
.globl fft_cols_kernel
.p2align 8
.type fft_cols_kernel,@function
fft_cols_kernel:
    s_load_dwordx2 s[6:7], s[0:1], 80
    v_and_b32 v1, 63, v0
    v_lshrrev_b32 v3, 6, v0
    s_cmp_ge_u32 s2, 289
    s_cbranch_scc1 K2_SIDE
    v_readfirstlane_b32 s3, v3
    s_lshr_b32 s28, s2, 5
    s_add_u32 s28, s28, 1
    s_and_b32 s29, s2, 31
    s_cmp_lt_u32 s2, 256
    s_cbranch_scc1 K2_A
    s_mov_b32 s28, 0
    s_sub_u32 s29, s2, 256
    s_cmp_lt_u32 s2, 273
    s_cbranch_scc1 K2_A
    s_mov_b32 s28, 9
    s_sub_u32 s29, s2, 273
K2_A:
    s_lshl_b32 s30, s28, 5
    s_add_u32 s30, s30, s29
    s_lshl_b32 s30, s30, 13
    s_mul_i32 s31, s29, 18
    s_add_u32 s31, s31, s28
    s_sub_u32 s32, 576, s31
    s_cmp_gt_u32 s31, 288
    s_cselect_b32 s32, s32, s31
    s_cselect_b32 s33, -1, 0
    s_cselect_b32 s34, 0x80000000, 0
    s_lshl_b32 s32, s32, 13
    s_add_u32 s32, s32, 0x600000
    s_mov_b32 s35, 2.0
    s_cmp_eq_u32 s31, 0
    s_cselect_b32 s35, 1.0, s35
    s_cmp_eq_u32 s31, 288
    s_cselect_b32 s35, 1.0, s35
    v_lshrrev_b32 v13, 4, v1
    v_and_b32 v14, 15, v1
    s_lshl_b32 s38, s3, 4
    v_add_u32 v15, s38, v14
    v_lshl_add_u32 v3, v13, 8, v15
    v_cvt_f32_u32 v15, v15
    v_cvt_f32_u32 v16, v13
    v_cvt_f32_u32 v17, v14
    v_mul_f32 v18, v15, v16
    v_mul_f32 v19, 0x3d800000, v18
    v_fmamk_f32 v20, v15, 0x00000000, v19
    v_fmamk_f32 v21, v15, 0x3c800000, v19
    v_fmamk_f32 v22, v15, 0x3d000000, v19
    v_fmamk_f32 v23, v15, 0x3d400000, v19
    v_fmamk_f32 v24, v15, 0x3e800000, v19
    v_fmamk_f32 v25, v15, 0x3e880000, v19
    v_fmamk_f32 v26, v15, 0x3e900000, v19
    v_fmamk_f32 v27, v15, 0x3e980000, v19
    v_cos_f32 v28, v20
    v_cos_f32 v29, v21
    v_cos_f32 v30, v22
    v_cos_f32 v31, v23
    v_cos_f32 v32, v24
    v_cos_f32 v33, v25
    v_cos_f32 v34, v26
    v_cos_f32 v35, v27
    v_sin_f32 v36, v20
    v_sin_f32 v37, v21
    v_sin_f32 v38, v22
    v_sin_f32 v39, v23
    v_sin_f32 v40, v24
    v_sin_f32 v41, v25
    v_sin_f32 v42, v26
    v_sin_f32 v43, v27
    v_cvt_pk_f16_f32 v96, v28, v29
    v_cvt_pk_f16_f32 v97, v30, v31
    v_cvt_pk_f16_f32 v98, v32, v33
    v_cvt_pk_f16_f32 v99, v34, v35
    v_cvt_pk_f16_f32 v100, v36, v37
    v_cvt_pk_f16_f32 v101, v38, v39
    v_cvt_pk_f16_f32 v102, v40, v41
    v_cvt_pk_f16_f32 v103, v42, v43
    v_xor_b32 v104, 0x80008000, v100
    v_xor_b32 v105, 0x80008000, v101
    v_xor_b32 v106, 0x80008000, v102
    v_xor_b32 v107, 0x80008000, v103
    v_fmamk_f32 v20, v15, 0x3f000000, v19
    v_fmamk_f32 v21, v15, 0x3f040000, v19
    v_fmamk_f32 v22, v15, 0x3f080000, v19
    v_fmamk_f32 v23, v15, 0x3f0c0000, v19
    v_fmamk_f32 v24, v15, 0x3f400000, v19
    v_fmamk_f32 v25, v15, 0x3f440000, v19
    v_fmamk_f32 v26, v15, 0x3f480000, v19
    v_fmamk_f32 v27, v15, 0x3f4c0000, v19
    v_cos_f32 v28, v20
    v_cos_f32 v29, v21
    v_cos_f32 v30, v22
    v_cos_f32 v31, v23
    v_cos_f32 v32, v24
    v_cos_f32 v33, v25
    v_cos_f32 v34, v26
    v_cos_f32 v35, v27
    v_sin_f32 v36, v20
    v_sin_f32 v37, v21
    v_sin_f32 v38, v22
    v_sin_f32 v39, v23
    v_sin_f32 v40, v24
    v_sin_f32 v41, v25
    v_sin_f32 v42, v26
    v_sin_f32 v43, v27
    v_cvt_pk_f16_f32 v108, v28, v29
    v_cvt_pk_f16_f32 v109, v30, v31
    v_cvt_pk_f16_f32 v110, v32, v33
    v_cvt_pk_f16_f32 v111, v34, v35
    v_cvt_pk_f16_f32 v112, v36, v37
    v_cvt_pk_f16_f32 v113, v38, v39
    v_cvt_pk_f16_f32 v114, v40, v41
    v_cvt_pk_f16_f32 v115, v42, v43
    v_xor_b32 v116, 0x80008000, v112
    v_xor_b32 v117, 0x80008000, v113
    v_xor_b32 v118, 0x80008000, v114
    v_xor_b32 v119, 0x80008000, v115
    v_lshlrev_b32 v2, 4, v1
    s_waitcnt lgkmcnt(0)
    s_mov_b32 s16, s6
    s_and_b32 s17, s7, 0xffff
    s_mov_b32 s18, 0x2000000
    s_mov_b32 s19, 0x00020000
    s_add_u32 s36, s30, 4096
    s_lshl_b32 s39, s3, 13
    s_add_u32 s39, s39, 0x908000
    s_add_u32 s40, s39, 4096
    buffer_load_dwordx4 v[64:67], v2, s[16:19], s30 offen offset:0
    buffer_load_dwordx4 v[68:71], v2, s[16:19], s30 offen offset:1024
    buffer_load_dwordx4 v[72:75], v2, s[16:19], s30 offen offset:2048
    buffer_load_dwordx4 v[76:79], v2, s[16:19], s30 offen offset:3072
    buffer_load_dwordx4 v[80:83], v2, s[16:19], s36 offen offset:0
    buffer_load_dwordx4 v[84:87], v2, s[16:19], s36 offen offset:1024
    buffer_load_dwordx4 v[88:91], v2, s[16:19], s36 offen offset:2048
    buffer_load_dwordx4 v[92:95], v2, s[16:19], s36 offen offset:3072
    s_mov_b32 s37, 0x900000
    buffer_load_dwordx4 v[56:59], v2, s[16:19], s37 offen
    v_add_u32 v4, 0, v3
    v_xor_b32 v4, s33, v4
    v_subrev_u32 v4, s33, v4
    v_and_b32 v4, 0x7ff, v4
    v_lshlrev_b32 v4, 2, v4
    buffer_load_dword v48, v4, s[16:19], s32 offen
    v_add_u32 v4, 64, v3
    v_xor_b32 v4, s33, v4
    v_subrev_u32 v4, s33, v4
    v_and_b32 v4, 0x7ff, v4
    v_lshlrev_b32 v4, 2, v4
    buffer_load_dword v49, v4, s[16:19], s32 offen
    v_add_u32 v4, 128, v3
    v_xor_b32 v4, s33, v4
    v_subrev_u32 v4, s33, v4
    v_and_b32 v4, 0x7ff, v4
    v_lshlrev_b32 v4, 2, v4
    buffer_load_dword v50, v4, s[16:19], s32 offen
    v_add_u32 v4, 192, v3
    v_xor_b32 v4, s33, v4
    v_subrev_u32 v4, s33, v4
    v_and_b32 v4, 0x7ff, v4
    v_lshlrev_b32 v4, 2, v4
    buffer_load_dword v51, v4, s[16:19], s32 offen
    v_add_u32 v4, 1024, v3
    v_xor_b32 v4, s33, v4
    v_subrev_u32 v4, s33, v4
    v_and_b32 v4, 0x7ff, v4
    v_lshlrev_b32 v4, 2, v4
    buffer_load_dword v52, v4, s[16:19], s32 offen
    v_add_u32 v4, 1088, v3
    v_xor_b32 v4, s33, v4
    v_subrev_u32 v4, s33, v4
    v_and_b32 v4, 0x7ff, v4
    v_lshlrev_b32 v4, 2, v4
    buffer_load_dword v53, v4, s[16:19], s32 offen
    v_add_u32 v4, 1152, v3
    v_xor_b32 v4, s33, v4
    v_subrev_u32 v4, s33, v4
    v_and_b32 v4, 0x7ff, v4
    v_lshlrev_b32 v4, 2, v4
    buffer_load_dword v54, v4, s[16:19], s32 offen
    v_add_u32 v4, 1216, v3
    v_xor_b32 v4, s33, v4
    v_subrev_u32 v4, s33, v4
    v_and_b32 v4, 0x7ff, v4
    v_lshlrev_b32 v4, 2, v4
    buffer_load_dword v55, v4, s[16:19], s32 offen
    v_add_f32 v4, 0x00000000, v17
    v_mul_f32 v5, v4, v16
    v_mul_f32 v5, 0x3e000000, v5
    v_fmamk_f32 v20, v4, 0x00000000, v5
    v_fmamk_f32 v21, v4, 0x3d000000, v5
    v_fmamk_f32 v22, v4, 0x3d800000, v5
    v_fmamk_f32 v23, v4, 0x3dc00000, v5
    v_fmamk_f32 v24, v4, 0x3f000000, v5
    v_fmamk_f32 v25, v4, 0x3f080000, v5
    v_fmamk_f32 v26, v4, 0x3f100000, v5
    v_fmamk_f32 v27, v4, 0x3f180000, v5
    v_cos_f32 v28, v20
    v_cos_f32 v29, v21
    v_cos_f32 v30, v22
    v_cos_f32 v31, v23
    v_cos_f32 v32, v24
    v_cos_f32 v33, v25
    v_cos_f32 v34, v26
    v_cos_f32 v35, v27
    v_sin_f32 v36, v20
    v_sin_f32 v37, v21
    v_sin_f32 v38, v22
    v_sin_f32 v39, v23
    v_sin_f32 v40, v24
    v_sin_f32 v41, v25
    v_sin_f32 v42, v26
    v_sin_f32 v43, v27
    v_cvt_pk_f16_f32 v120, v28, v29
    v_cvt_pk_f16_f32 v121, v30, v31
    v_cvt_pk_f16_f32 v122, v32, v33
    v_cvt_pk_f16_f32 v123, v34, v35
    v_cvt_pk_f16_f32 v124, v36, v37
    v_cvt_pk_f16_f32 v125, v38, v39
    v_cvt_pk_f16_f32 v126, v40, v41
    v_cvt_pk_f16_f32 v127, v42, v43
    v_xor_b32 v128, 0x80008000, v124
    v_xor_b32 v129, 0x80008000, v125
    v_xor_b32 v130, 0x80008000, v126
    v_xor_b32 v131, 0x80008000, v127
    v_add_f32 v4, 0x41800000, v17
    v_mul_f32 v5, v4, v16
    v_mul_f32 v5, 0x3e000000, v5
    v_fmamk_f32 v20, v4, 0x00000000, v5
    v_fmamk_f32 v21, v4, 0x3d000000, v5
    v_fmamk_f32 v22, v4, 0x3d800000, v5
    v_fmamk_f32 v23, v4, 0x3dc00000, v5
    v_fmamk_f32 v24, v4, 0x3f000000, v5
    v_fmamk_f32 v25, v4, 0x3f080000, v5
    v_fmamk_f32 v26, v4, 0x3f100000, v5
    v_fmamk_f32 v27, v4, 0x3f180000, v5
    v_cos_f32 v28, v20
    v_cos_f32 v29, v21
    v_cos_f32 v30, v22
    v_cos_f32 v31, v23
    v_cos_f32 v32, v24
    v_cos_f32 v33, v25
    v_cos_f32 v34, v26
    v_cos_f32 v35, v27
    v_sin_f32 v36, v20
    v_sin_f32 v37, v21
    v_sin_f32 v38, v22
    v_sin_f32 v39, v23
    v_sin_f32 v40, v24
    v_sin_f32 v41, v25
    v_sin_f32 v42, v26
    v_sin_f32 v43, v27
    v_cvt_pk_f16_f32 v132, v28, v29
    v_cvt_pk_f16_f32 v133, v30, v31
    v_cvt_pk_f16_f32 v134, v32, v33
    v_cvt_pk_f16_f32 v135, v34, v35
    v_cvt_pk_f16_f32 v136, v36, v37
    v_cvt_pk_f16_f32 v137, v38, v39
    v_cvt_pk_f16_f32 v138, v40, v41
    v_cvt_pk_f16_f32 v139, v42, v43
    v_xor_b32 v140, 0x80008000, v136
    v_xor_b32 v141, 0x80008000, v137
    v_xor_b32 v142, 0x80008000, v138
    v_xor_b32 v143, 0x80008000, v139
    v_mul_f32 v19, 0x3b000000, v18
    v_fmamk_f32 v20, v15, 0x00000000, v19
    v_fmamk_f32 v21, v15, 0x3a000000, v19
    v_fmamk_f32 v22, v15, 0x3a800000, v19
    v_fmamk_f32 v23, v15, 0x3ac00000, v19
    v_fmamk_f32 v24, v15, 0x3c000000, v19
    v_fmamk_f32 v25, v15, 0x3c080000, v19
    v_fmamk_f32 v26, v15, 0x3c100000, v19
    v_fmamk_f32 v27, v15, 0x3c180000, v19
    v_lshlrev_b32 v4, 2, v13
    v_add_u32 v4, s38, v4
    v_cvt_f32_u32 v4, v4
    v_mul_f32 v4, 0x3a000000, v4
    v_add_f32 v5, 0x00000000, v17
    v_mul_f32 v6, v5, v4
    v_fmamk_f32 v28, v5, 0x00000000, v6
    v_fmamk_f32 v29, v5, 0x3a000000, v6
    v_fmamk_f32 v30, v5, 0x3a800000, v6
    v_fmamk_f32 v31, v5, 0x3ac00000, v6
    v_add_f32 v5, 0x41800000, v17
    v_mul_f32 v6, v5, v4
    v_fmamk_f32 v32, v5, 0x00000000, v6
    v_fmamk_f32 v33, v5, 0x3a000000, v6
    v_fmamk_f32 v34, v5, 0x3a800000, v6
    v_fmamk_f32 v35, v5, 0x3ac00000, v6
    v_cos_f32 v144, v20
    v_sin_f32 v152, v20
    v_cos_f32 v160, v28
    v_sin_f32 v168, v28
    v_cos_f32 v145, v21
    v_sin_f32 v153, v21
    v_cos_f32 v161, v29
    v_sin_f32 v169, v29
    v_cos_f32 v146, v22
    v_sin_f32 v154, v22
    v_cos_f32 v162, v30
    v_sin_f32 v170, v30
    v_cos_f32 v147, v23
    v_sin_f32 v155, v23
    v_cos_f32 v163, v31
    v_sin_f32 v171, v31
    v_cos_f32 v148, v24
    v_sin_f32 v156, v24
    v_cos_f32 v164, v32
    v_sin_f32 v172, v32
    v_cos_f32 v149, v25
    v_sin_f32 v157, v25
    v_cos_f32 v165, v33
    v_sin_f32 v173, v33
    v_cos_f32 v150, v26
    v_sin_f32 v158, v26
    v_cos_f32 v166, v34
    v_sin_f32 v174, v34
    v_cos_f32 v151, v27
    v_sin_f32 v159, v27
    v_cos_f32 v167, v35
    v_sin_f32 v175, v35
    s_nop 0
    v_mul_f32 v144, 0x3cb504f3, v144
    v_mul_f32 v145, 0x3cb504f3, v145
    v_mul_f32 v146, 0x3cb504f3, v146
    v_mul_f32 v147, 0x3cb504f3, v147
    v_mul_f32 v148, 0x3cb504f3, v148
    v_mul_f32 v149, 0x3cb504f3, v149
    v_mul_f32 v150, 0x3cb504f3, v150
    v_mul_f32 v151, 0x3cb504f3, v151
    v_mul_f32 v152, 0x3cb504f3, v152
    v_mul_f32 v153, 0x3cb504f3, v153
    v_mul_f32 v154, 0x3cb504f3, v154
    v_mul_f32 v155, 0x3cb504f3, v155
    v_mul_f32 v156, 0x3cb504f3, v156
    v_mul_f32 v157, 0x3cb504f3, v157
    v_mul_f32 v158, 0x3cb504f3, v158
    v_mul_f32 v159, 0x3cb504f3, v159
    v_mul_f32 v160, 0x3cb504f3, v160
    v_mul_f32 v161, 0x3cb504f3, v161
    v_mul_f32 v162, 0x3cb504f3, v162
    v_mul_f32 v163, 0x3cb504f3, v163
    v_mul_f32 v164, 0x3cb504f3, v164
    v_mul_f32 v165, 0x3cb504f3, v165
    v_mul_f32 v166, 0x3cb504f3, v166
    v_mul_f32 v167, 0x3cb504f3, v167
    v_mul_f32 v168, 0x3cb504f3, v168
    v_mul_f32 v169, 0x3cb504f3, v169
    v_mul_f32 v170, 0x3cb504f3, v170
    v_mul_f32 v171, 0x3cb504f3, v171
    v_mul_f32 v172, 0x3cb504f3, v172
    v_mul_f32 v173, 0x3cb504f3, v173
    v_mul_f32 v174, 0x3cb504f3, v174
    v_mul_f32 v175, 0x3cb504f3, v175
    s_waitcnt vmcnt(9)
    v_mfma_f32_16x16x32_f16 v[20:23], v[64:67], v[96:99], 0
    v_mfma_f32_16x16x32_f16 v[28:31], v[80:83], v[96:99], 0
    v_mfma_f32_16x16x32_f16 v[20:23], v[80:83], v[100:103], v[20:23]
    v_mfma_f32_16x16x32_f16 v[28:31], v[64:67], v[104:107], v[28:31]
    v_mfma_f32_16x16x32_f16 v[20:23], v[72:75], v[108:111], v[20:23]
    v_mfma_f32_16x16x32_f16 v[28:31], v[88:91], v[108:111], v[28:31]
    v_mfma_f32_16x16x32_f16 v[20:23], v[88:91], v[112:115], v[20:23]
    v_mfma_f32_16x16x32_f16 v[28:31], v[72:75], v[116:119], v[28:31]
    v_mfma_f32_16x16x32_f16 v[24:27], v[68:71], v[96:99], 0
    v_mfma_f32_16x16x32_f16 v[32:35], v[84:87], v[96:99], 0
    v_mfma_f32_16x16x32_f16 v[24:27], v[84:87], v[100:103], v[24:27]
    v_mfma_f32_16x16x32_f16 v[32:35], v[68:71], v[104:107], v[32:35]
    v_mfma_f32_16x16x32_f16 v[24:27], v[76:79], v[108:111], v[24:27]
    v_mfma_f32_16x16x32_f16 v[32:35], v[92:95], v[108:111], v[32:35]
    v_mfma_f32_16x16x32_f16 v[24:27], v[92:95], v[112:115], v[24:27]
    v_mfma_f32_16x16x32_f16 v[32:35], v[76:79], v[116:119], v[32:35]
    s_waitcnt vmcnt(8)
    v_max3_u32 v56, v56, v57, v58
    v_max_u32 v56, v56, v59
    s_nop 1
    v_max_u32_dpp v56, v56, v56 quad_perm:[1,0,3,2] row_mask:0xf bank_mask:0xf
    s_nop 1
    v_max_u32_dpp v56, v56, v56 quad_perm:[2,3,0,1] row_mask:0xf bank_mask:0xf
    s_nop 1
    v_max_u32_dpp v56, v56, v56 row_half_mirror row_mask:0xf bank_mask:0xf
    s_nop 1
    v_max_u32_dpp v56, v56, v56 row_mirror row_mask:0xf bank_mask:0xf
    v_mov_b32 v57, v56
    s_nop 1
    v_permlane16_swap_b32 v56, v57
    v_max_u32 v56, v56, v57
    v_mov_b32 v57, v56
    s_nop 1
    v_permlane32_swap_b32 v56, v57
    v_max_u32 v56, v56, v57
    v_lshrrev_b32 v56, 7, v56
    v_max_u32 v56, 1, v56
    v_min_u32 v56, 0xfd, v56
    v_sub_u32 v56, 0xfe, v56
    v_lshlrev_b32 v56, 23, v56
    v_mul_f32 v56, s35, v56
    v_mul_f32 v4, v20, v144
    v_mul_f32 v8, v28, v144
    v_fmac_f32 v4, v28, v152
    v_fma_f32 v8, -v20, v152, v8
    v_mul_f32 v5, v21, v145
    v_mul_f32 v9, v29, v145
    v_fmac_f32 v5, v29, v153
    v_fma_f32 v9, -v21, v153, v9
    v_mul_f32 v6, v22, v146
    v_mul_f32 v10, v30, v146
    v_fmac_f32 v6, v30, v154
    v_fma_f32 v10, -v22, v154, v10
    v_mul_f32 v7, v23, v147
    v_mul_f32 v11, v31, v147
    v_fmac_f32 v7, v31, v155
    v_fma_f32 v11, -v23, v155, v11
    v_cvt_pk_f16_f32 v36, v4, v5
    v_cvt_pk_f16_f32 v37, v6, v7
    v_cvt_pk_f16_f32 v40, v8, v9
    v_cvt_pk_f16_f32 v41, v10, v11
    v_mul_f32 v4, v24, v148
    v_mul_f32 v8, v32, v148
    v_fmac_f32 v4, v32, v156
    v_fma_f32 v8, -v24, v156, v8
    v_mul_f32 v5, v25, v149
    v_mul_f32 v9, v33, v149
    v_fmac_f32 v5, v33, v157
    v_fma_f32 v9, -v25, v157, v9
    v_mul_f32 v6, v26, v150
    v_mul_f32 v10, v34, v150
    v_fmac_f32 v6, v34, v158
    v_fma_f32 v10, -v26, v158, v10
    v_mul_f32 v7, v27, v151
    v_mul_f32 v11, v35, v151
    v_fmac_f32 v7, v35, v159
    v_fma_f32 v11, -v27, v159, v11
    v_cvt_pk_f16_f32 v38, v4, v5
    v_cvt_pk_f16_f32 v39, v6, v7
    v_cvt_pk_f16_f32 v42, v8, v9
    v_cvt_pk_f16_f32 v43, v10, v11
    s_nop 1
    v_mfma_f32_16x16x32_f16 v[64:67], v[120:123], v[36:39], 0
    v_mfma_f32_16x16x32_f16 v[72:75], v[120:123], v[40:43], 0
    v_mfma_f32_16x16x32_f16 v[64:67], v[124:127], v[40:43], v[64:67]
    v_mfma_f32_16x16x32_f16 v[72:75], v[128:131], v[36:39], v[72:75]
    v_mfma_f32_16x16x32_f16 v[68:71], v[132:135], v[36:39], 0
    v_mfma_f32_16x16x32_f16 v[76:79], v[132:135], v[40:43], 0
    v_mfma_f32_16x16x32_f16 v[68:71], v[136:139], v[40:43], v[68:71]
    v_mfma_f32_16x16x32_f16 v[76:79], v[140:143], v[36:39], v[76:79]
    s_waitcnt vmcnt(0)
    v_lshlrev_b32 v80, 16, v48
    v_and_b32 v88, 0xffff0000, v48
    v_xor_b32 v88, s34, v88
    v_mul_f32 v80, v56, v80
    v_mul_f32 v88, v56, v88
    v_lshlrev_b32 v81, 16, v49
    v_and_b32 v89, 0xffff0000, v49
    v_xor_b32 v89, s34, v89
    v_mul_f32 v81, v56, v81
    v_mul_f32 v89, v56, v89
    v_lshlrev_b32 v82, 16, v50
    v_and_b32 v90, 0xffff0000, v50
    v_xor_b32 v90, s34, v90
    v_mul_f32 v82, v56, v82
    v_mul_f32 v90, v56, v90
    v_lshlrev_b32 v83, 16, v51
    v_and_b32 v91, 0xffff0000, v51
    v_xor_b32 v91, s34, v91
    v_mul_f32 v83, v56, v83
    v_mul_f32 v91, v56, v91
    v_lshlrev_b32 v84, 16, v52
    v_and_b32 v92, 0xffff0000, v52
    v_xor_b32 v92, s34, v92
    v_mul_f32 v84, v56, v84
    v_mul_f32 v92, v56, v92
    v_lshlrev_b32 v85, 16, v53
    v_and_b32 v93, 0xffff0000, v53
    v_xor_b32 v93, s34, v93
    v_mul_f32 v85, v56, v85
    v_mul_f32 v93, v56, v93
    v_lshlrev_b32 v86, 16, v54
    v_and_b32 v94, 0xffff0000, v54
    v_xor_b32 v94, s34, v94
    v_mul_f32 v86, v56, v86
    v_mul_f32 v94, v56, v94
    v_lshlrev_b32 v87, 16, v55
    v_and_b32 v95, 0xffff0000, v55
    v_xor_b32 v95, s34, v95
    v_mul_f32 v87, v56, v87
    v_mul_f32 v95, v56, v95
    v_mul_f32 v4, v64, v80
    v_mul_f32 v8, v72, v80
    v_fma_f32 v4, -v72, v88, v4
    v_fmac_f32 v8, v64, v88
    v_mul_f32 v5, v65, v81
    v_mul_f32 v9, v73, v81
    v_fma_f32 v5, -v73, v89, v5
    v_fmac_f32 v9, v65, v89
    v_mul_f32 v6, v66, v82
    v_mul_f32 v10, v74, v82
    v_fma_f32 v6, -v74, v90, v6
    v_fmac_f32 v10, v66, v90
    v_mul_f32 v7, v67, v83
    v_mul_f32 v11, v75, v83
    v_fma_f32 v7, -v75, v91, v7
    v_fmac_f32 v11, v67, v91
    v_cvt_pk_f16_f32 v36, v4, v5
    v_cvt_pk_f16_f32 v37, v6, v7
    v_cvt_pk_f16_f32 v40, v8, v9
    v_cvt_pk_f16_f32 v41, v10, v11
    v_mul_f32 v4, v68, v84
    v_mul_f32 v8, v76, v84
    v_fma_f32 v4, -v76, v92, v4
    v_fmac_f32 v8, v68, v92
    v_mul_f32 v5, v69, v85
    v_mul_f32 v9, v77, v85
    v_fma_f32 v5, -v77, v93, v5
    v_fmac_f32 v9, v69, v93
    v_mul_f32 v6, v70, v86
    v_mul_f32 v10, v78, v86
    v_fma_f32 v6, -v78, v94, v6
    v_fmac_f32 v10, v70, v94
    v_mul_f32 v7, v71, v87
    v_mul_f32 v11, v79, v87
    v_fma_f32 v7, -v79, v95, v7
    v_fmac_f32 v11, v71, v95
    v_cvt_pk_f16_f32 v38, v4, v5
    v_cvt_pk_f16_f32 v39, v6, v7
    v_cvt_pk_f16_f32 v42, v8, v9
    v_cvt_pk_f16_f32 v43, v10, v11
    s_nop 1
    v_mfma_f32_16x16x32_f16 v[20:23], v[36:39], v[120:123], 0
    v_mfma_f32_16x16x32_f16 v[28:31], v[40:43], v[120:123], 0
    v_mfma_f32_16x16x32_f16 v[20:23], v[40:43], v[128:131], v[20:23]
    v_mfma_f32_16x16x32_f16 v[28:31], v[36:39], v[124:127], v[28:31]
    v_mfma_f32_16x16x32_f16 v[24:27], v[36:39], v[132:135], 0
    v_mfma_f32_16x16x32_f16 v[32:35], v[40:43], v[132:135], 0
    v_mfma_f32_16x16x32_f16 v[24:27], v[40:43], v[140:143], v[24:27]
    v_mfma_f32_16x16x32_f16 v[32:35], v[36:39], v[136:139], v[32:35]
    s_lshl_b32 s39, s3, 11
    v_lshlrev_b32 v3, 3, v1
    v_add_u32 v4, s39, v3
    s_nop 4
    v_mul_f32 v8, v20, v160
    v_mul_f32 v12, v28, v160
    v_fma_f32 v8, -v28, v168, v8
    v_fmac_f32 v12, v20, v168
    v_mul_f32 v9, v21, v161
    v_mul_f32 v13, v29, v161
    v_fma_f32 v9, -v29, v169, v9
    v_fmac_f32 v13, v21, v169
    v_mul_f32 v10, v22, v162
    v_mul_f32 v14, v30, v162
    v_fma_f32 v10, -v30, v170, v10
    v_fmac_f32 v14, v22, v170
    v_mul_f32 v11, v23, v163
    v_mul_f32 v15, v31, v163
    v_fma_f32 v11, -v31, v171, v11
    v_fmac_f32 v15, v23, v171
    v_cvt_pk_f16_f32 v36, v8, v9
    v_cvt_pk_f16_f32 v37, v10, v11
    v_cvt_pk_f16_f32 v38, v12, v13
    v_cvt_pk_f16_f32 v39, v14, v15
    v_mul_f32 v8, v24, v164
    v_mul_f32 v12, v32, v164
    v_fma_f32 v8, -v32, v172, v8
    v_fmac_f32 v12, v24, v172
    v_mul_f32 v9, v25, v165
    v_mul_f32 v13, v33, v165
    v_fma_f32 v9, -v33, v173, v9
    v_fmac_f32 v13, v25, v173
    v_mul_f32 v10, v26, v166
    v_mul_f32 v14, v34, v166
    v_fma_f32 v10, -v34, v174, v10
    v_fmac_f32 v14, v26, v174
    v_mul_f32 v11, v27, v167
    v_mul_f32 v15, v35, v167
    v_fma_f32 v11, -v35, v175, v11
    v_fmac_f32 v15, v27, v175
    v_cvt_pk_f16_f32 v40, v8, v9
    v_cvt_pk_f16_f32 v41, v10, v11
    v_cvt_pk_f16_f32 v42, v12, v13
    v_cvt_pk_f16_f32 v43, v14, v15
    ds_write_b64 v4, v[36:37] offset:0
    ds_write_b64 v4, v[38:39] offset:512
    ds_write_b64 v4, v[40:41] offset:1024
    ds_write_b64 v4, v[42:43] offset:1536
    s_waitcnt lgkmcnt(0)
    s_barrier
    ds_read_b64 v[64:65], v3 offset:0
    ds_read_b64 v[66:67], v3 offset:2048
    ds_read_b64 v[68:69], v3 offset:512
    ds_read_b64 v[70:71], v3 offset:2560
    ds_read_b64 v[72:73], v3 offset:1024
    ds_read_b64 v[74:75], v3 offset:3072
    ds_read_b64 v[76:77], v3 offset:1536
    ds_read_b64 v[78:79], v3 offset:3584
    ds_read_b64 v[80:81], v3 offset:4096
    ds_read_b64 v[82:83], v3 offset:6144
    ds_read_b64 v[84:85], v3 offset:4608
    ds_read_b64 v[86:87], v3 offset:6656
    ds_read_b64 v[88:89], v3 offset:5120
    ds_read_b64 v[90:91], v3 offset:7168
    ds_read_b64 v[92:93], v3 offset:5632
    ds_read_b64 v[94:95], v3 offset:7680
    s_add_u32 s40, s30, 0x300000
    s_lshl_b32 s39, s3, 10
    s_add_u32 s40, s40, s39
    s_add_u32 s41, s40, 4096
    s_waitcnt lgkmcnt(8)
    v_mfma_f32_16x16x32_f16 v[20:23], v[96:99], v[64:67], 0
    v_mfma_f32_16x16x32_f16 v[28:31], v[96:99], v[68:71], 0
    v_mfma_f32_16x16x32_f16 v[20:23], v[104:107], v[68:71], v[20:23]
    v_mfma_f32_16x16x32_f16 v[28:31], v[100:103], v[64:67], v[28:31]
    v_mfma_f32_16x16x32_f16 v[24:27], v[96:99], v[72:75], 0
    v_mfma_f32_16x16x32_f16 v[32:35], v[96:99], v[76:79], 0
    v_mfma_f32_16x16x32_f16 v[24:27], v[104:107], v[76:79], v[24:27]
    v_mfma_f32_16x16x32_f16 v[32:35], v[100:103], v[72:75], v[32:35]
    s_waitcnt lgkmcnt(0)
    v_mfma_f32_16x16x32_f16 v[20:23], v[108:111], v[80:83], v[20:23]
    v_mfma_f32_16x16x32_f16 v[28:31], v[108:111], v[84:87], v[28:31]
    v_mfma_f32_16x16x32_f16 v[20:23], v[116:119], v[84:87], v[20:23]
    v_mfma_f32_16x16x32_f16 v[28:31], v[112:115], v[80:83], v[28:31]
    v_mfma_f32_16x16x32_f16 v[24:27], v[108:111], v[88:91], v[24:27]
    v_mfma_f32_16x16x32_f16 v[32:35], v[108:111], v[92:95], v[32:35]
    v_mfma_f32_16x16x32_f16 v[24:27], v[116:119], v[92:95], v[24:27]
    v_mfma_f32_16x16x32_f16 v[32:35], v[112:115], v[88:91], v[32:35]
    s_nop 7
    v_cvt_pk_f16_f32 v36, v20, v21
    v_cvt_pk_f16_f32 v37, v22, v23
    v_cvt_pk_f16_f32 v38, v24, v25
    v_cvt_pk_f16_f32 v39, v26, v27
    v_cvt_pk_f16_f32 v40, v28, v29
    v_cvt_pk_f16_f32 v41, v30, v31
    v_cvt_pk_f16_f32 v42, v32, v33
    v_cvt_pk_f16_f32 v43, v34, v35
    buffer_store_dwordx4 v[36:39], v2, s[16:19], s40 offen sc0 sc1
    buffer_store_dwordx4 v[40:43], v2, s[16:19], s41 offen sc0 sc1
    s_endpgm
K2_SIDE:
    s_sub_u32 s28, s2, 289
    s_cmp_ge_u32 s28, 216
    s_cbranch_scc1 K2_END
    s_waitcnt lgkmcnt(0)
    s_load_dwordx4 s[8:11], s[0:1], 40
    s_load_dwordx2 s[4:5], s[0:1], 56
    s_load_dwordx2 s[6:7], s[0:1], 80
    v_readfirstlane_b32 s3, v3
    s_lshl_b32 s28, s28, 2
    s_add_u32 s28, s28, s3
    s_add_u32 s28, s28, 0
    s_mul_i32 s33, s28, 6144
    s_add_u32 s38, s33, 3072
    s_cmp_ge_u32 s28, 864
    s_cselect_b32 s36, 864, 0
    s_cselect_b32 s37, 0x600000, 0
    s_sub_u32 s28, s28, s36
    s_mul_i32 s29, s28, 43691
    s_lshr_b32 s29, s29, 18
    s_mul_i32 s30, s29, 6
    s_sub_u32 s30, s28, s30
    s_mul_i32 s31, s29, 36864
    s_mul_i32 s32, s30, 1536
    s_add_u32 s31, s31, s32
    s_mul_i32 s32, s30, 884736
    s_lshl_b32 s34, s29, 7
    s_add_u32 s32, s32, s34
    s_add_u32 s32, s32, s37
    v_lshrrev_b32 v4, 3, v1
    v_bfe_u32 v5, v1, 1, 2
    v_and_b32 v6, 1, v1
    v_mul_u32_u24 v5, 9216, v5
    v_lshl_add_u32 v5, v4, 5, v5
    v_lshl_add_u32 v5, v6, 4, v5
    v_and_b32 v6, 7, v1
    v_mul_u32_u24 v4, 18432, v4
    v_lshl_add_u32 v4, v6, 4, v4
    v_lshlrev_b32 v6, 4, v1
    s_waitcnt lgkmcnt(0)
    s_mov_b32 s16, s6
    s_and_b32 s17, s7, 0xffff
    s_mov_b32 s18, 0x2000000
    s_mov_b32 s19, 0x00020000
    s_mov_b32 s20, s8
    s_and_b32 s21, s9, 0xffff
    s_mov_b32 s22, 0x510000
    s_mov_b32 s23, 0x00020000
    s_mov_b32 s24, s10
    s_and_b32 s25, s11, 0xffff
    s_mov_b32 s26, 0x510000
    s_mov_b32 s27, 0x00020000
    s_mov_b32 s12, s4
    s_and_b32 s13, s5, 0xffff
    s_mov_b32 s14, 0x510000
    s_mov_b32 s15, 0x00020000
    s_sleep 6
    buffer_load_dwordx4 v[8:11], v5, s[20:23], s31 offen offset:0
    buffer_load_dwordx4 v[12:15], v5, s[20:23], s31 offen offset:256
    buffer_load_dwordx4 v[16:19], v5, s[20:23], s31 offen offset:512
    buffer_load_dwordx4 v[20:23], v5, s[20:23], s31 offen offset:768
    buffer_load_dwordx4 v[24:27], v5, s[20:23], s31 offen offset:1024
    buffer_load_dwordx4 v[28:31], v5, s[20:23], s31 offen offset:1280
    s_waitcnt vmcnt(0)
    s_add_u32 s35, s32, 0x1400000
    buffer_store_dwordx4 v[8:11], v4, s[16:19], s35 offen sc0 sc1
    s_add_u32 s35, s32, 0x1424000
    buffer_store_dwordx4 v[12:15], v4, s[16:19], s35 offen sc0 sc1
    s_add_u32 s35, s32, 0x1448000
    buffer_store_dwordx4 v[16:19], v4, s[16:19], s35 offen sc0 sc1
    s_add_u32 s35, s32, 0x146c000
    buffer_store_dwordx4 v[20:23], v4, s[16:19], s35 offen sc0 sc1
    s_add_u32 s35, s32, 0x1490000
    buffer_store_dwordx4 v[24:27], v4, s[16:19], s35 offen sc0 sc1
    s_add_u32 s35, s32, 0x14b4000
    buffer_store_dwordx4 v[28:31], v4, s[16:19], s35 offen sc0 sc1
    s_waitcnt vmcnt(0)
K2_END:
    s_endpgm
.text
.globl ifft_rows_kernel
.p2align 8
.type ifft_rows_kernel,@function
ifft_rows_kernel:
    s_load_dwordx2 s[4:5], s[0:1], 0
    s_load_dwordx2 s[8:9], s[0:1], 32
    s_load_dwordx2 s[10:11], s[0:1], 64
    s_load_dwordx2 s[6:7], s[0:1], 80
    v_and_b32 v1, 63, v0
    v_lshrrev_b32 v3, 6, v0
    s_cmp_ge_u32 s2, 256
    s_cbranch_scc1 K3_SIDE
    v_readfirstlane_b32 s3, v3
    s_lshr_b32 s28, s2, 5
    s_and_b32 s29, s2, 1
    s_lshl_b32 s29, s29, 3
    s_add_u32 s28, s28, s29
    s_bfe_u32 s29, s2, 0x40001
    s_lshl_b32 s30, s29, 8
    s_lshl_b32 s31, s28, 4
    s_add_u32 s30, s30, s31
    s_add_u32 s30, s30, 0x300000
    s_add_u32 s31, s30, 4096
    v_mov_b32 v10, 0x7fffffff
    v_lshlrev_b32 v2, 13, v0
    v_subrev_u32 v4, 17, v0
    v_cmp_gt_u32 vcc, 15, v4
    v_and_b32 v5, 63, v0
    v_add_u32 v6, 0x100, v5
    v_cndmask_b32 v2, v2, v10, vcc
    v_lshlrev_b32 v3, 13, v6
    v_bfe_u32 v7, v0, 6, 1
    v_lshl_add_u32 v3, v7, 12, v3
    v_cmp_lt_u32 vcc, 0x7f, v0
    v_cmp_lt_u32 s[32:33], 47, v5
    s_or_b64 vcc, vcc, s[32:33]
    s_waitcnt lgkmcnt(0)
    s_mov_b32 s16, s6
    s_and_b32 s17, s7, 0xffff
    s_mov_b32 s18, 0x2000000
    s_mov_b32 s19, 0x00020000
    s_mov_b32 s12, s4
    s_and_b32 s13, s5, 0xffff
    s_mov_b32 s14, 0x240000
    s_mov_b32 s15, 0x00020000
    s_mov_b32 s20, s8
    s_and_b32 s21, s9, 0xffff
    s_mov_b32 s22, 0x480
    s_mov_b32 s23, 0x00020000
    s_mov_b32 s24, s10
    s_and_b32 s25, s11, 0xffff
    s_mov_b32 s26, 0x240000
    s_mov_b32 s27, 0x00020000
    v_cndmask_b32 v3, v3, v10, vcc
    buffer_load_dwordx4 v[64:67], v2, s[16:19], s30 offen
    buffer_load_dwordx4 v[68:71], v2, s[16:19], s31 offen
    buffer_load_dwordx4 v[72:75], v3, s[16:19], s30 offen
    v_lshlrev_b32 v2, 4, v1
    s_mov_b32 s37, 0x900000
    buffer_load_dwordx4 v[56:59], v2, s[16:19], s37 offen
    s_lshr_b32 s32, s3, 1
    s_and_b32 s33, s3, 1
    s_lshl_b32 s34, s29, 2
    s_lshl_b32 s35, s33, 1
    s_add_u32 s34, s34, s35
    s_lshl_b32 s34, s34, 5
    s_lshl_b32 s35, s32, 4
    s_add_u32 s34, s34, s35
    s_add_u32 s34, s34, s28
    s_mul_i32 s35, s34, 1152
    v_lshrrev_b32 v8, 5, v1
    v_and_b32 v9, 31, v1
    v_lshlrev_b32 v11, 4, v9
    v_lshlrev_b32 v9, 2, v9
    v_mul_u32_u24 v12, 36864, v8
    v_add_u32 v99, v12, v9
    v_add_u32 v12, v12, v11
    buffer_load_dwordx4 v[100:103], v12, s[12:15], s35 offen
    buffer_load_dwordx4 v[104:107], v12, s[12:15], s35 offen offset:512
    buffer_load_dword v108, v99, s[12:15], s35 offen offset:1024
    buffer_load_dwordx4 v[110:113], v11, s[20:23], 0 offen
    buffer_load_dwordx4 v[114:117], v11, s[20:23], 0 offen offset:512
    buffer_load_dword v118, v9, s[20:23], 0 offen offset:1024
    v_and_b32 v4, 31, v0
    v_mul_u32_u24 v4, 176, v4
    v_lshrrev_b32 v5, 5, v0
    v_lshl_add_u32 v4, v5, 4, v4
    v_and_b32 v5, 31, v6
    v_mul_u32_u24 v5, 176, v5
    v_lshrrev_b32 v6, 5, v6
    v_lshl_add_u32 v5, v6, 4, v5
    v_mul_u32_u24 v7, 5632, v7
    v_add_u32 v5, v5, v7
    v_lshrrev_b32 v13, 4, v1
    v_and_b32 v14, 15, v1
    s_lshl_b32 s36, s33, 4
    v_add_u32 v15, s36, v14
    v_cvt_f32_u32 v15, v15
    v_cvt_f32_u32 v16, v13
    v_cvt_f32_u32 v17, v14
    v_mul_f32 v18, v15, v16
    v_mul_f32 v19, 0x3e800000, v18
    v_fmamk_f32 v20, v15, 0x00000000, v19
    v_fmamk_f32 v21, v15, 0x3d000000, v19
    v_fmamk_f32 v22, v15, 0x3d800000, v19
    v_fmamk_f32 v23, v15, 0x3dc00000, v19
    v_fmamk_f32 v24, v15, 0x3e000000, v19
    v_fmamk_f32 v25, v15, 0x3e200000, v19
    v_fmamk_f32 v26, v15, 0x3e400000, v19
    v_fmamk_f32 v27, v15, 0x3e600000, v19
    v_cos_f32 v28, v20
    v_cos_f32 v29, v21
    v_cos_f32 v30, v22
    v_cos_f32 v31, v23
    v_cos_f32 v32, v24
    v_cos_f32 v33, v25
    v_cos_f32 v34, v26
    v_cos_f32 v35, v27
    v_sin_f32 v36, v20
    v_sin_f32 v37, v21
    v_sin_f32 v38, v22
    v_sin_f32 v39, v23
    v_sin_f32 v40, v24
    v_sin_f32 v41, v25
    v_sin_f32 v42, v26
    v_sin_f32 v43, v27
    v_cvt_pk_f16_f32 v120, v28, v29
    v_cvt_pk_f16_f32 v121, v30, v31
    v_cvt_pk_f16_f32 v122, v32, v33
    v_cvt_pk_f16_f32 v123, v34, v35
    v_cvt_pk_f16_f32 v124, v36, v37
    v_cvt_pk_f16_f32 v125, v38, v39
    v_cvt_pk_f16_f32 v126, v40, v41
    v_cvt_pk_f16_f32 v127, v42, v43
    v_xor_b32 v128, 0x80008000, v124
    v_xor_b32 v129, 0x80008000, v125
    v_xor_b32 v130, 0x80008000, v126
    v_xor_b32 v131, 0x80008000, v127
    v_mul_f32 v19, 0x3ae38e39, v18
    v_fmamk_f32 v20, v15, 0x00000000, v19
    v_fmamk_f32 v21, v15, 0x3be38e39, v19
    v_fmamk_f32 v22, v15, 0x3c638e39, v19
    v_cos_f32 v132, v20
    v_sin_f32 v135, v20
    v_cos_f32 v133, v21
    v_sin_f32 v136, v21
    v_cos_f32 v134, v22
    v_sin_f32 v137, v22
    v_add_f32 v24, 0x00000000, v17
    v_mul_f32 v25, v24, v16
    v_mul_f32 v25, 0x3d638e39, v25
    v_fmamk_f32 v26, v24, 0x00000000, v25
    v_fmamk_f32 v27, v24, 0x3e638e39, v25
    v_fmamk_f32 v28, v24, 0x3ee38e39, v25
    v_cos_f32 v30, v26
    v_sin_f32 v33, v26
    v_cos_f32 v31, v27
    v_sin_f32 v34, v27
    v_cos_f32 v32, v28
    v_sin_f32 v35, v28
    s_nop 0
    v_cvt_pk_f16_f32 v140, v30, -v33
    v_cvt_pk_f16_f32 v141, v31, -v34
    v_cvt_pk_f16_f32 v142, v32, -v35
    v_mov_b32 v143, 0
    v_add_f32 v24, 0x41800000, v17
    v_mul_f32 v25, v24, v16
    v_mul_f32 v25, 0x3d638e39, v25
    v_fmamk_f32 v26, v24, 0x00000000, v25
    v_fmamk_f32 v27, v24, 0x3e638e39, v25
    v_fmamk_f32 v28, v24, 0x3ee38e39, v25
    v_cos_f32 v30, v26
    v_sin_f32 v33, v26
    v_cos_f32 v31, v27
    v_sin_f32 v34, v27
    v_cos_f32 v32, v28
    v_sin_f32 v35, v28
    s_nop 0
    v_cvt_pk_f16_f32 v144, v30, -v33
    v_cvt_pk_f16_f32 v145, v31, -v34
    v_cvt_pk_f16_f32 v146, v32, -v35
    v_mov_b32 v147, 0
    s_mov_b32 exec_lo, 0x0
    s_mov_b32 exec_hi, 0xffffffff
    v_mov_b32 v142, 0
    v_mov_b32 v146, 0
    s_mov_b64 exec, -1
    v_mul_f32 v132, 0x3d2aaaab, v132
    v_mul_f32 v133, 0x3d2aaaab, v133
    v_mul_f32 v134, 0x3d2aaaab, v134
    v_mul_f32 v135, 0x3d2aaaab, v135
    v_mul_f32 v136, 0x3d2aaaab, v136
    v_mul_f32 v137, 0x3d2aaaab, v137
    v_bfe_u32 v6, v1, 2, 2
    v_lshl_add_u32 v6, v13, 3, v6
    v_mul_u32_u24 v6, 176, v6
    s_lshl_b32 s36, s32, 3
    v_add_u32 v6, s36, v6
    v_and_b32 v7, 3, v1
    v_min_u32 v19, 1, v7
    v_lshl_add_u32 v19, v19, 4, v6
    v_lshl_add_u32 v6, v7, 4, v6
    s_waitcnt vmcnt(7)
    ds_write_b128 v4, v[64:67]
    ds_write_b128 v4, v[68:71] offset:5632
    v_cmp_gt_u32 vcc, 0x80, v0
    s_and_saveexec_b64 s[38:39], vcc
    ds_write_b128 v5, v[72:75]
    s_mov_b64 exec, -1
    s_waitcnt vmcnt(6)
    v_max3_u32 v56, v56, v57, v58
    v_max_u32 v56, v56, v59
    s_nop 1
    v_max_u32_dpp v56, v56, v56 quad_perm:[1,0,3,2] row_mask:0xf bank_mask:0xf
    s_nop 1
    v_max_u32_dpp v56, v56, v56 quad_perm:[2,3,0,1] row_mask:0xf bank_mask:0xf
    s_nop 1
    v_max_u32_dpp v56, v56, v56 row_half_mirror row_mask:0xf bank_mask:0xf
    s_nop 1
    v_max_u32_dpp v56, v56, v56 row_mirror row_mask:0xf bank_mask:0xf
    v_mov_b32 v57, v56
    s_nop 1
    v_permlane16_swap_b32 v56, v57
    v_max_u32 v56, v56, v57
    v_mov_b32 v57, v56
    s_nop 1
    v_permlane32_swap_b32 v56, v57
    v_max_u32 v56, v56, v57
    v_lshrrev_b32 v56, 7, v56
    v_max_u32 v56, 1, v56
    v_min_u32 v56, 0xfd, v56
    v_lshlrev_b32 v56, 23, v56
    s_waitcnt lgkmcnt(0)
    s_barrier
    ds_read_b64_tr_b16 v[64:65], v6 offset:0
    ds_read_b64_tr_b16 v[66:67], v6 offset:704
    ds_read_b64_tr_b16 v[68:69], v6 offset:5632
    ds_read_b64_tr_b16 v[70:71], v6 offset:6336
    ds_read_b64_tr_b16 v[72:73], v6 offset:64
    ds_read_b64_tr_b16 v[74:75], v6 offset:768
    ds_read_b64_tr_b16 v[76:77], v6 offset:5696
    ds_read_b64_tr_b16 v[78:79], v6 offset:6400
    ds_read_b64_tr_b16 v[80:81], v19 offset:128
    ds_read_b64_tr_b16 v[82:83], v19 offset:832
    ds_read_b64_tr_b16 v[84:85], v19 offset:5760
    ds_read_b64_tr_b16 v[86:87], v19 offset:6464
    s_waitcnt lgkmcnt(8)
    v_mfma_f32_16x16x32_f16 v[20:23], v[64:67], v[120:123], 0
    v_mfma_f32_16x16x32_f16 v[24:27], v[68:71], v[120:123], 0
    v_mfma_f32_16x16x32_f16 v[20:23], v[68:71], v[128:131], v[20:23]
    v_mfma_f32_16x16x32_f16 v[24:27], v[64:67], v[124:127], v[24:27]
    s_waitcnt lgkmcnt(4)
    v_mfma_f32_16x16x32_f16 v[28:31], v[72:75], v[120:123], 0
    v_mfma_f32_16x16x32_f16 v[32:35], v[76:79], v[120:123], 0
    v_mfma_f32_16x16x32_f16 v[28:31], v[76:79], v[128:131], v[28:31]
    v_mfma_f32_16x16x32_f16 v[32:35], v[72:75], v[124:127], v[32:35]
    s_waitcnt lgkmcnt(0)
    v_mfma_f32_16x16x32_f16 v[36:39], v[80:83], v[120:123], 0
    v_mfma_f32_16x16x32_f16 v[40:43], v[84:87], v[120:123], 0
    v_mfma_f32_16x16x32_f16 v[36:39], v[84:87], v[128:131], v[36:39]
    v_mfma_f32_16x16x32_f16 v[40:43], v[80:83], v[124:127], v[40:43]
    s_mul_i32 s36, s32, 4672
    s_lshl_b32 s38, s33, 5
    s_add_u32 s36, s36, s38
    s_add_u32 s36, s36, 11264
    v_lshlrev_b32 v4, 6, v14
    v_lshl_add_u32 v4, v13, 3, v4
    v_add_u32 v4, s36, v4
    s_nop 1
    v_mov_b32 v67, 0
    v_mov_b32 v71, 0
    v_mov_b32 v75, 0
    v_mov_b32 v79, 0
    v_mul_f32 v44, v20, v132
    v_mul_f32 v45, v24, v132
    v_fma_f32 v44, -v24, v135, v44
    v_fmac_f32 v45, v20, v135
    v_cvt_pk_f16_f32 v64, v44, v45
    v_mul_f32 v44, v21, v132
    v_mul_f32 v45, v25, v132
    v_fma_f32 v44, -v25, v135, v44
    v_fmac_f32 v45, v21, v135
    v_cvt_pk_f16_f32 v68, v44, v45
    v_mul_f32 v44, v22, v132
    v_mul_f32 v45, v26, v132
    v_fma_f32 v44, -v26, v135, v44
    v_fmac_f32 v45, v22, v135
    v_cvt_pk_f16_f32 v72, v44, v45
    v_mul_f32 v44, v23, v132
    v_mul_f32 v45, v27, v132
    v_fma_f32 v44, -v27, v135, v44
    v_fmac_f32 v45, v23, v135
    v_cvt_pk_f16_f32 v76, v44, v45
    v_mul_f32 v44, v28, v133
    v_mul_f32 v45, v32, v133
    v_fma_f32 v44, -v32, v136, v44
    v_fmac_f32 v45, v28, v136
    v_cvt_pk_f16_f32 v65, v44, v45
    v_mul_f32 v44, v29, v133
    v_mul_f32 v45, v33, v133
    v_fma_f32 v44, -v33, v136, v44
    v_fmac_f32 v45, v29, v136
    v_cvt_pk_f16_f32 v69, v44, v45
    v_mul_f32 v44, v30, v133
    v_mul_f32 v45, v34, v133
    v_fma_f32 v44, -v34, v136, v44
    v_fmac_f32 v45, v30, v136
    v_cvt_pk_f16_f32 v73, v44, v45
    v_mul_f32 v44, v31, v133
    v_mul_f32 v45, v35, v133
    v_fma_f32 v44, -v35, v136, v44
    v_fmac_f32 v45, v31, v136
    v_cvt_pk_f16_f32 v77, v44, v45
    v_mul_f32 v44, v36, v134
    v_mul_f32 v45, v40, v134
    v_fma_f32 v44, -v40, v137, v44
    v_fmac_f32 v45, v36, v137
    v_cvt_pk_f16_f32 v66, v44, v45
    v_mul_f32 v44, v37, v134
    v_mul_f32 v45, v41, v134
    v_fma_f32 v44, -v41, v137, v44
    v_fmac_f32 v45, v37, v137
    v_cvt_pk_f16_f32 v70, v44, v45
    v_mul_f32 v44, v38, v134
    v_mul_f32 v45, v42, v134
    v_fma_f32 v44, -v42, v137, v44
    v_fmac_f32 v45, v38, v137
    v_cvt_pk_f16_f32 v74, v44, v45
    v_mul_f32 v44, v39, v134
    v_mul_f32 v45, v43, v134
    v_fma_f32 v44, -v43, v137, v44
    v_fmac_f32 v45, v39, v137
    v_cvt_pk_f16_f32 v78, v44, v45
    s_nop 1
    v_mfma_f32_16x16x32_f16 v[20:23], v[64:67], v[140:143], 0
    v_mfma_f32_16x16x32_f16 v[24:27], v[64:67], v[144:147], 0
    v_mfma_f32_16x16x32_f16 v[28:31], v[68:71], v[140:143], 0
    v_mfma_f32_16x16x32_f16 v[32:35], v[68:71], v[144:147], 0
    v_mfma_f32_16x16x32_f16 v[36:39], v[72:75], v[140:143], 0
    v_mfma_f32_16x16x32_f16 v[40:43], v[72:75], v[144:147], 0
    v_mfma_f32_16x16x32_f16 v[44:47], v[76:79], v[140:143], 0
    v_mfma_f32_16x16x32_f16 v[48:51], v[76:79], v[144:147], 0
    s_nop 4
    v_mul_f32 v20, v56, v20
    v_mul_f32 v21, v56, v21
    v_mul_f32 v22, v56, v22
    v_mul_f32 v23, v56, v23
    v_cvt_pk_bf16_f32 v20, v20, v21
    v_cvt_pk_bf16_f32 v21, v22, v23
    v_mul_f32 v24, v56, v24
    v_mul_f32 v25, v56, v25
    v_mul_f32 v26, v56, v26
    v_mul_f32 v27, v56, v27
    v_cvt_pk_bf16_f32 v24, v24, v25
    v_cvt_pk_bf16_f32 v25, v26, v27
    ds_write_b64 v4, v[20:21] offset:0
    v_mul_f32 v28, v56, v28
    v_mul_f32 v29, v56, v29
    v_mul_f32 v30, v56, v30
    v_mul_f32 v31, v56, v31
    v_cvt_pk_bf16_f32 v28, v28, v29
    v_cvt_pk_bf16_f32 v29, v30, v31
    v_mul_f32 v32, v56, v32
    v_mul_f32 v33, v56, v33
    v_mul_f32 v34, v56, v34
    v_mul_f32 v35, v56, v35
    v_cvt_pk_bf16_f32 v32, v32, v33
    v_cvt_pk_bf16_f32 v33, v34, v35
    ds_write_b64 v4, v[28:29] offset:1168
    v_mul_f32 v36, v56, v36
    v_mul_f32 v37, v56, v37
    v_mul_f32 v38, v56, v38
    v_mul_f32 v39, v56, v39
    v_cvt_pk_bf16_f32 v36, v36, v37
    v_cvt_pk_bf16_f32 v37, v38, v39
    v_mul_f32 v40, v56, v40
    v_mul_f32 v41, v56, v41
    v_mul_f32 v42, v56, v42
    v_mul_f32 v43, v56, v43
    v_cvt_pk_bf16_f32 v40, v40, v41
    v_cvt_pk_bf16_f32 v41, v42, v43
    ds_write_b64 v4, v[36:37] offset:2336
    v_mul_f32 v44, v56, v44
    v_mul_f32 v45, v56, v45
    v_mul_f32 v46, v56, v46
    v_mul_f32 v47, v56, v47
    v_cvt_pk_bf16_f32 v44, v44, v45
    v_cvt_pk_bf16_f32 v45, v46, v47
    v_mul_f32 v48, v56, v48
    v_mul_f32 v49, v56, v49
    v_mul_f32 v50, v56, v50
    v_mul_f32 v51, v56, v51
    v_cvt_pk_bf16_f32 v48, v48, v49
    v_cvt_pk_bf16_f32 v49, v50, v51
    ds_write_b64 v4, v[44:45] offset:3504
    s_mov_b32 exec_lo, 0x30003
    s_mov_b32 exec_hi, 0x30003
    ds_write_b64 v4, v[24:25] offset:1024
    ds_write_b64 v4, v[32:33] offset:2192
    ds_write_b64 v4, v[40:41] offset:3360
    ds_write_b64 v4, v[48:49] offset:4528
    s_mov_b64 exec, -1
    s_mul_i32 s36, s3, 2336
    s_add_u32 s36, s36, 11264
    v_mul_u32_u24 v4, 1168, v8
    v_add3_u32 v5, v4, v9, s36
    v_add3_u32 v4, v4, v11, s36
    s_waitcnt lgkmcnt(0)
    s_barrier
    ds_read_b128 v[20:23], v4
    ds_read_b128 v[24:27], v4 offset:512
    ds_read_b32 v28, v5 offset:1024
    s_waitcnt vmcnt(0)
    v_lshlrev_b32 v64, 16, v100
    v_and_b32 v65, 0xffff0000, v100
    v_lshlrev_b32 v66, 16, v101
    v_and_b32 v67, 0xffff0000, v101
    v_lshlrev_b32 v68, 16, v102
    v_and_b32 v69, 0xffff0000, v102
    v_lshlrev_b32 v70, 16, v103
    v_and_b32 v71, 0xffff0000, v103
    v_lshlrev_b32 v72, 16, v104
    v_and_b32 v73, 0xffff0000, v104
    v_lshlrev_b32 v74, 16, v105
    v_and_b32 v75, 0xffff0000, v105
    v_lshlrev_b32 v76, 16, v106
    v_and_b32 v77, 0xffff0000, v106
    v_lshlrev_b32 v78, 16, v107
    v_and_b32 v79, 0xffff0000, v107
    v_lshlrev_b32 v80, 16, v108
    v_and_b32 v81, 0xffff0000, v108
    s_waitcnt lgkmcnt(0)
    v_lshlrev_b32 v30, 16, v20
    v_and_b32 v31, 0xffff0000, v20
    v_lshlrev_b32 v32, 16, v21
    v_and_b32 v33, 0xffff0000, v21
    v_lshlrev_b32 v34, 16, v22
    v_and_b32 v35, 0xffff0000, v22
    v_lshlrev_b32 v36, 16, v23
    v_and_b32 v37, 0xffff0000, v23
    v_lshlrev_b32 v38, 16, v24
    v_and_b32 v39, 0xffff0000, v24
    v_lshlrev_b32 v40, 16, v25
    v_and_b32 v41, 0xffff0000, v25
    v_lshlrev_b32 v42, 16, v26
    v_and_b32 v43, 0xffff0000, v26
    v_lshlrev_b32 v44, 16, v27
    v_and_b32 v45, 0xffff0000, v27
    v_lshlrev_b32 v46, 16, v28
    v_and_b32 v47, 0xffff0000, v28
    v_add_f32 v64, v64, v30
    v_add_f32 v65, v65, v31
    v_add_f32 v66, v66, v32
    v_add_f32 v67, v67, v33
    v_add_f32 v68, v68, v34
    v_add_f32 v69, v69, v35
    v_add_f32 v70, v70, v36
    v_add_f32 v71, v71, v37
    v_add_f32 v72, v72, v38
    v_add_f32 v73, v73, v39
    v_add_f32 v74, v74, v40
    v_add_f32 v75, v75, v41
    v_add_f32 v76, v76, v42
    v_add_f32 v77, v77, v43
    v_add_f32 v78, v78, v44
    v_add_f32 v79, v79, v45
    v_add_f32 v80, v80, v46
    v_add_f32 v81, v81, v47
    v_cvt_pk_bf16_f32 v100, v64, v65
    v_cvt_pk_bf16_f32 v101, v66, v67
    v_cvt_pk_bf16_f32 v102, v68, v69
    v_cvt_pk_bf16_f32 v103, v70, v71
    v_cvt_pk_bf16_f32 v104, v72, v73
    v_cvt_pk_bf16_f32 v105, v74, v75
    v_cvt_pk_bf16_f32 v106, v76, v77
    v_cvt_pk_bf16_f32 v107, v78, v79
    v_cvt_pk_bf16_f32 v108, v80, v81
    s_add_u32 s36, s35, 0xa00000
    s_add_u32 s37, s35, 0xd00000
    v_lshlrev_b32 v64, 16, v100
    v_and_b32 v65, 0xffff0000, v100
    v_lshlrev_b32 v66, 16, v101
    v_and_b32 v67, 0xffff0000, v101
    v_lshlrev_b32 v68, 16, v102
    v_and_b32 v69, 0xffff0000, v102
    v_lshlrev_b32 v70, 16, v103
    v_and_b32 v71, 0xffff0000, v103
    v_lshlrev_b32 v72, 16, v104
    v_and_b32 v73, 0xffff0000, v104
    v_lshlrev_b32 v74, 16, v105
    v_and_b32 v75, 0xffff0000, v105
    v_lshlrev_b32 v76, 16, v106
    v_and_b32 v77, 0xffff0000, v106
    v_lshlrev_b32 v78, 16, v107
    v_and_b32 v79, 0xffff0000, v107
    v_lshlrev_b32 v80, 16, v108
    v_and_b32 v81, 0xffff0000, v108
    v_lshlrev_b32 v30, 16, v100
    v_and_b32 v31, 0xffff0000, v100
    v_lshlrev_b32 v32, 16, v101
    v_and_b32 v33, 0xffff0000, v101
    v_lshlrev_b32 v34, 16, v102
    v_and_b32 v35, 0xffff0000, v102
    v_lshlrev_b32 v36, 16, v103
    v_and_b32 v37, 0xffff0000, v103
    v_lshlrev_b32 v38, 16, v104
    v_and_b32 v39, 0xffff0000, v104
    v_lshlrev_b32 v40, 16, v105
    v_and_b32 v41, 0xffff0000, v105
    v_lshlrev_b32 v42, 16, v106
    v_and_b32 v43, 0xffff0000, v106
    v_lshlrev_b32 v44, 16, v107
    v_and_b32 v45, 0xffff0000, v107
    v_lshlrev_b32 v46, 16, v108
    v_and_b32 v47, 0xffff0000, v108
    v_add_f32 v120, v64, v65
    v_add_f32 v120, v120, v66
    v_add_f32 v120, v120, v67
    v_add_f32 v120, v120, v68
    v_add_f32 v120, v120, v69
    v_add_f32 v120, v120, v70
    v_add_f32 v120, v120, v71
    v_add_f32 v120, v120, v72
    v_add_f32 v120, v120, v73
    v_add_f32 v120, v120, v74
    v_add_f32 v120, v120, v75
    v_add_f32 v120, v120, v76
    v_add_f32 v120, v120, v77
    v_add_f32 v120, v120, v78
    v_add_f32 v120, v120, v79
    v_add_f32 v120, v120, v80
    v_add_f32 v120, v120, v81
    s_nop 1
    v_add_f32_dpp v120, v120, v120 quad_perm:[1,0,3,2] row_mask:0xf bank_mask:0xf
    s_nop 1
    v_add_f32_dpp v120, v120, v120 quad_perm:[2,3,0,1] row_mask:0xf bank_mask:0xf
    s_nop 1
    v_add_f32_dpp v120, v120, v120 row_half_mirror row_mask:0xf bank_mask:0xf
    s_nop 1
    v_add_f32_dpp v120, v120, v120 row_mirror row_mask:0xf bank_mask:0xf
    v_mov_b32 v121, v120
    s_nop 1
    v_permlane16_swap_b32 v120, v121
    v_add_f32 v120, v120, v121
    v_mul_f32 v120, 0x3ae38e39, v120
    v_sub_f32 v123, v64, v120
    v_mul_f32 v122, v123, v123
    v_sub_f32 v124, v65, v120
    v_fmac_f32 v122, v124, v124
    v_sub_f32 v123, v66, v120
    v_fmac_f32 v122, v123, v123
    v_sub_f32 v124, v67, v120
    v_fmac_f32 v122, v124, v124
    v_sub_f32 v123, v68, v120
    v_fmac_f32 v122, v123, v123
    v_sub_f32 v124, v69, v120
    v_fmac_f32 v122, v124, v124
    v_sub_f32 v123, v70, v120
    v_fmac_f32 v122, v123, v123
    v_sub_f32 v124, v71, v120
    v_fmac_f32 v122, v124, v124
    v_sub_f32 v123, v72, v120
    v_fmac_f32 v122, v123, v123
    v_sub_f32 v124, v73, v120
    v_fmac_f32 v122, v124, v124
    v_sub_f32 v123, v74, v120
    v_fmac_f32 v122, v123, v123
    v_sub_f32 v124, v75, v120
    v_fmac_f32 v122, v124, v124
    v_sub_f32 v123, v76, v120
    v_fmac_f32 v122, v123, v123
    v_sub_f32 v124, v77, v120
    v_fmac_f32 v122, v124, v124
    v_sub_f32 v123, v78, v120
    v_fmac_f32 v122, v123, v123
    v_sub_f32 v124, v79, v120
    v_fmac_f32 v122, v124, v124
    v_sub_f32 v123, v80, v120
    v_fmac_f32 v122, v123, v123
    v_sub_f32 v124, v81, v120
    v_fmac_f32 v122, v124, v124
    s_nop 1
    v_add_f32_dpp v122, v122, v122 quad_perm:[1,0,3,2] row_mask:0xf bank_mask:0xf
    s_nop 1
    v_add_f32_dpp v122, v122, v122 quad_perm:[2,3,0,1] row_mask:0xf bank_mask:0xf
    s_nop 1
    v_add_f32_dpp v122, v122, v122 row_half_mirror row_mask:0xf bank_mask:0xf
    s_nop 1
    v_add_f32_dpp v122, v122, v122 row_mirror row_mask:0xf bank_mask:0xf
    v_mov_b32 v121, v122
    s_nop 1
    v_permlane16_swap_b32 v122, v121
    v_add_f32 v122, v122, v121
    v_mul_f32 v122, 0x3ae38e39, v122
    v_cvt_pk_bf16_f32 v121, v120, v120
    v_lshlrev_b32 v120, 16, v121
    v_cvt_pk_bf16_f32 v121, v122, v122
    v_lshlrev_b32 v122, 16, v121
    v_add_f32 v122, 0x3727c5ac, v122
    v_cvt_pk_bf16_f32 v121, v122, v122
    v_lshlrev_b32 v122, 16, v121
    v_sqrt_f32 v122, v122
    s_nop 0
    v_cvt_pk_bf16_f32 v121, v122, v122
    v_lshlrev_b32 v122, 16, v121
    v_rcp_f32 v123, v122
    v_sub_f32 v64, v64, v120
    v_sub_f32 v65, v65, v120
    v_cvt_pk_bf16_f32 v84, v64, v65
    v_sub_f32 v66, v66, v120
    v_sub_f32 v67, v67, v120
    v_cvt_pk_bf16_f32 v85, v66, v67
    v_sub_f32 v68, v68, v120
    v_sub_f32 v69, v69, v120
    v_cvt_pk_bf16_f32 v86, v68, v69
    v_sub_f32 v70, v70, v120
    v_sub_f32 v71, v71, v120
    v_cvt_pk_bf16_f32 v87, v70, v71
    v_sub_f32 v72, v72, v120
    v_sub_f32 v73, v73, v120
    v_cvt_pk_bf16_f32 v88, v72, v73
    v_sub_f32 v74, v74, v120
    v_sub_f32 v75, v75, v120
    v_cvt_pk_bf16_f32 v89, v74, v75
    v_sub_f32 v76, v76, v120
    v_sub_f32 v77, v77, v120
    v_cvt_pk_bf16_f32 v90, v76, v77
    v_sub_f32 v78, v78, v120
    v_sub_f32 v79, v79, v120
    v_cvt_pk_bf16_f32 v91, v78, v79
    v_sub_f32 v80, v80, v120
    v_sub_f32 v81, v81, v120
    v_cvt_pk_bf16_f32 v92, v80, v81
    v_lshlrev_b32 v64, 16, v84
    v_and_b32 v65, 0xffff0000, v84
    v_lshlrev_b32 v66, 16, v85
    v_and_b32 v67, 0xffff0000, v85
    v_lshlrev_b32 v68, 16, v86
    v_and_b32 v69, 0xffff0000, v86
    v_lshlrev_b32 v70, 16, v87
    v_and_b32 v71, 0xffff0000, v87
    v_lshlrev_b32 v72, 16, v88
    v_and_b32 v73, 0xffff0000, v88
    v_lshlrev_b32 v74, 16, v89
    v_and_b32 v75, 0xffff0000, v89
    v_lshlrev_b32 v76, 16, v90
    v_and_b32 v77, 0xffff0000, v90
    v_lshlrev_b32 v78, 16, v91
    v_and_b32 v79, 0xffff0000, v91
    v_lshlrev_b32 v80, 16, v92
    v_and_b32 v81, 0xffff0000, v92
    v_mul_f32 v124, v64, v123
    v_fma_f32 v125, -v124, v122, v64
    v_fma_f32 v64, v125, v123, v124
    v_mul_f32 v126, v65, v123
    v_fma_f32 v127, -v126, v122, v65
    v_fma_f32 v65, v127, v123, v126
    v_mul_f32 v124, v66, v123
    v_fma_f32 v125, -v124, v122, v66
    v_fma_f32 v66, v125, v123, v124
    v_mul_f32 v126, v67, v123
    v_fma_f32 v127, -v126, v122, v67
    v_fma_f32 v67, v127, v123, v126
    v_mul_f32 v124, v68, v123
    v_fma_f32 v125, -v124, v122, v68
    v_fma_f32 v68, v125, v123, v124
    v_mul_f32 v126, v69, v123
    v_fma_f32 v127, -v126, v122, v69
    v_fma_f32 v69, v127, v123, v126
    v_mul_f32 v124, v70, v123
    v_fma_f32 v125, -v124, v122, v70
    v_fma_f32 v70, v125, v123, v124
    v_mul_f32 v126, v71, v123
    v_fma_f32 v127, -v126, v122, v71
    v_fma_f32 v71, v127, v123, v126
    v_mul_f32 v124, v72, v123
    v_fma_f32 v125, -v124, v122, v72
    v_fma_f32 v72, v125, v123, v124
    v_mul_f32 v126, v73, v123
    v_fma_f32 v127, -v126, v122, v73
    v_fma_f32 v73, v127, v123, v126
    v_mul_f32 v124, v74, v123
    v_fma_f32 v125, -v124, v122, v74
    v_fma_f32 v74, v125, v123, v124
    v_mul_f32 v126, v75, v123
    v_fma_f32 v127, -v126, v122, v75
    v_fma_f32 v75, v127, v123, v126
    v_mul_f32 v124, v76, v123
    v_fma_f32 v125, -v124, v122, v76
    v_fma_f32 v76, v125, v123, v124
    v_mul_f32 v126, v77, v123
    v_fma_f32 v127, -v126, v122, v77
    v_fma_f32 v77, v127, v123, v126
    v_mul_f32 v124, v78, v123
    v_fma_f32 v125, -v124, v122, v78
    v_fma_f32 v78, v125, v123, v124
    v_mul_f32 v126, v79, v123
    v_fma_f32 v127, -v126, v122, v79
    v_fma_f32 v79, v127, v123, v126
    v_mul_f32 v124, v80, v123
    v_fma_f32 v125, -v124, v122, v80
    v_fma_f32 v80, v125, v123, v124
    v_mul_f32 v126, v81, v123
    v_fma_f32 v127, -v126, v122, v81
    v_fma_f32 v81, v127, v123, v126
    v_cvt_pk_bf16_f32 v84, v64, v65
    v_cvt_pk_bf16_f32 v85, v66, v67
    v_cvt_pk_bf16_f32 v86, v68, v69
    v_cvt_pk_bf16_f32 v87, v70, v71
    v_cvt_pk_bf16_f32 v88, v72, v73
    v_cvt_pk_bf16_f32 v89, v74, v75
    v_cvt_pk_bf16_f32 v90, v76, v77
    v_cvt_pk_bf16_f32 v91, v78, v79
    v_cvt_pk_bf16_f32 v92, v80, v81
    v_lshlrev_b32 v64, 16, v84
    v_and_b32 v65, 0xffff0000, v84
    v_lshlrev_b32 v66, 16, v85
    v_and_b32 v67, 0xffff0000, v85
    v_lshlrev_b32 v68, 16, v86
    v_and_b32 v69, 0xffff0000, v86
    v_lshlrev_b32 v70, 16, v87
    v_and_b32 v71, 0xffff0000, v87
    v_lshlrev_b32 v72, 16, v88
    v_and_b32 v73, 0xffff0000, v88
    v_lshlrev_b32 v74, 16, v89
    v_and_b32 v75, 0xffff0000, v89
    v_lshlrev_b32 v76, 16, v90
    v_and_b32 v77, 0xffff0000, v90
    v_lshlrev_b32 v78, 16, v91
    v_and_b32 v79, 0xffff0000, v91
    v_lshlrev_b32 v80, 16, v92
    v_and_b32 v81, 0xffff0000, v92
    v_lshlrev_b32 v120, 16, v110
    v_and_b32 v121, 0xffff0000, v110
    v_lshlrev_b32 v122, 16, v111
    v_and_b32 v123, 0xffff0000, v111
    v_lshlrev_b32 v124, 16, v112
    v_and_b32 v125, 0xffff0000, v112
    v_lshlrev_b32 v126, 16, v113
    v_and_b32 v127, 0xffff0000, v113
    v_lshlrev_b32 v128, 16, v114
    v_and_b32 v129, 0xffff0000, v114
    v_lshlrev_b32 v130, 16, v115
    v_and_b32 v131, 0xffff0000, v115
    v_lshlrev_b32 v132, 16, v116
    v_and_b32 v133, 0xffff0000, v116
    v_lshlrev_b32 v134, 16, v117
    v_and_b32 v135, 0xffff0000, v117
    v_lshlrev_b32 v136, 16, v118
    v_and_b32 v137, 0xffff0000, v118
    v_mul_f32 v50, v64, v120
    v_fmac_f32 v50, v65, v121
    v_fmac_f32 v50, v66, v122
    v_fmac_f32 v50, v67, v123
    v_fmac_f32 v50, v68, v124
    v_fmac_f32 v50, v69, v125
    v_fmac_f32 v50, v70, v126
    v_fmac_f32 v50, v71, v127
    v_fmac_f32 v50, v72, v128
    v_fmac_f32 v50, v73, v129
    v_fmac_f32 v50, v74, v130
    v_fmac_f32 v50, v75, v131
    v_fmac_f32 v50, v76, v132
    v_fmac_f32 v50, v77, v133
    v_fmac_f32 v50, v78, v134
    v_fmac_f32 v50, v79, v135
    v_fmac_f32 v50, v80, v136
    v_fmac_f32 v50, v81, v137
    s_nop 1
    v_add_f32_dpp v50, v50, v50 quad_perm:[1,0,3,2] row_mask:0xf bank_mask:0xf
    s_nop 1
    v_add_f32_dpp v50, v50, v50 quad_perm:[2,3,0,1] row_mask:0xf bank_mask:0xf
    s_nop 1
    v_add_f32_dpp v50, v50, v50 row_half_mirror row_mask:0xf bank_mask:0xf
    s_nop 1
    v_add_f32_dpp v50, v50, v50 row_mirror row_mask:0xf bank_mask:0xf
    v_mov_b32 v51, v50
    s_nop 1
    v_permlane16_swap_b32 v50, v51
    v_add_f32 v50, v50, v51
    v_cvt_pk_bf16_f32 v50, v50, v50
    v_and_b32 v50, 0xffff0000, v50
    v_ashrrev_i32 v51, 31, v50
    v_or_b32 v51, 0x80000000, v51
    v_xor_b32 v50, v50, v51
    v_and_b32 v50, 0xffff0000, v50
    v_lshlrev_b32 v52, 5, v8
    v_add_u32 v52, s34, v52
    v_sub_u32 v53, 0xffff, v52
    v_or_b32 v50, v50, v53
    s_lshl_b32 s38, s3, 3
    v_lshl_add_u32 v52, v8, 2, s38
    v_mov_b32 v53, 0
    ds_write_b32 v52, v50
    v_add_f32 v30, v30, v64
    v_add_f32 v31, v31, v65
    v_add_f32 v32, v32, v66
    v_add_f32 v33, v33, v67
    v_add_f32 v34, v34, v68
    v_add_f32 v35, v35, v69
    v_add_f32 v36, v36, v70
    v_add_f32 v37, v37, v71
    v_add_f32 v38, v38, v72
    v_add_f32 v39, v39, v73
    v_add_f32 v40, v40, v74
    v_add_f32 v41, v41, v75
    v_add_f32 v42, v42, v76
    v_add_f32 v43, v43, v77
    v_add_f32 v44, v44, v78
    v_add_f32 v45, v45, v79
    v_add_f32 v46, v46, v80
    v_add_f32 v47, v47, v81
    s_waitcnt lgkmcnt(0)
    s_barrier
    ds_read_b128 v[120:123], v53
    ds_read_b128 v[124:127], v53 offset:16
    v_cvt_pk_bf16_f32 v20, v30, v31
    v_cvt_pk_bf16_f32 v21, v32, v33
    v_cvt_pk_bf16_f32 v22, v34, v35
    v_cvt_pk_bf16_f32 v23, v36, v37
    v_cvt_pk_bf16_f32 v24, v38, v39
    v_cvt_pk_bf16_f32 v25, v40, v41
    v_cvt_pk_bf16_f32 v26, v42, v43
    v_cvt_pk_bf16_f32 v27, v44, v45
    v_cvt_pk_bf16_f32 v28, v46, v47
    buffer_store_dwordx4 v[20:23], v12, s[24:27], s35 offen sc0 sc1
    buffer_store_dwordx4 v[24:27], v12, s[24:27], s35 offen offset:512 sc0 sc1
    buffer_store_dword v28, v99, s[24:27], s35 offen offset:1024 sc0 sc1
    v_mov_b32 v54, 0
    s_waitcnt lgkmcnt(0)
    v_cmp_gt_u32 vcc, v120, v50
    v_addc_co_u32 v54, vcc, 0, v54, vcc
    v_cmp_gt_u32 vcc, v121, v50
    v_addc_co_u32 v54, vcc, 0, v54, vcc
    v_cmp_gt_u32 vcc, v122, v50
    v_addc_co_u32 v54, vcc, 0, v54, vcc
    v_cmp_gt_u32 vcc, v123, v50
    v_addc_co_u32 v54, vcc, 0, v54, vcc
    v_cmp_gt_u32 vcc, v124, v50
    v_addc_co_u32 v54, vcc, 0, v54, vcc
    v_cmp_gt_u32 vcc, v125, v50
    v_addc_co_u32 v54, vcc, 0, v54, vcc
    v_cmp_gt_u32 vcc, v126, v50
    v_addc_co_u32 v54, vcc, 0, v54, vcc
    v_cmp_gt_u32 vcc, v127, v50
    v_addc_co_u32 v54, vcc, 0, v54, vcc
    v_cmp_gt_u32 vcc, 2, v54
    s_lshl_b32 s38, s2, 3
    s_add_u32 s38, s38, 0x901000
    v_lshlrev_b32 v54, 2, v54
    s_and_b64 exec, exec, vcc
    s_cbranch_execz K3_NS
    buffer_store_dwordx4 v[100:103], v12, s[16:19], s36 offen sc0 sc1
    buffer_store_dwordx4 v[104:107], v12, s[16:19], s36 offen offset:512 sc0 sc1
    buffer_store_dword v108, v99, s[16:19], s36 offen offset:1024 sc0 sc1
    buffer_store_dwordx4 v[84:87], v12, s[16:19], s37 offen sc0 sc1
    buffer_store_dwordx4 v[88:91], v12, s[16:19], s37 offen offset:512 sc0 sc1
    buffer_store_dword v92, v99, s[16:19], s37 offen offset:1024 sc0 sc1
    s_and_b32 exec_lo, exec_lo, 1
    s_and_b32 exec_hi, exec_hi, 1
    buffer_store_dword v50, v54, s[16:19], s38 offen sc0 sc1
K3_NS:
    s_endpgm
K3_SIDE:
    s_sub_u32 s28, s2, 256
    s_cmp_ge_u32 s28, 216
    s_cbranch_scc1 K3_END
    s_waitcnt lgkmcnt(0)
    s_load_dwordx4 s[8:11], s[0:1], 40
    s_load_dwordx2 s[4:5], s[0:1], 56
    s_load_dwordx2 s[6:7], s[0:1], 80
    v_readfirstlane_b32 s3, v3
    s_lshl_b32 s28, s28, 2
    s_add_u32 s28, s28, s3
    s_add_u32 s28, s28, 864
    s_mul_i32 s33, s28, 6144
    s_add_u32 s38, s33, 3072
    s_cmp_ge_u32 s28, 864
    s_cselect_b32 s36, 864, 0
    s_cselect_b32 s37, 0x600000, 0
    s_sub_u32 s28, s28, s36
    s_mul_i32 s29, s28, 43691
    s_lshr_b32 s29, s29, 18
    s_mul_i32 s30, s29, 6
    s_sub_u32 s30, s28, s30
    s_mul_i32 s31, s29, 36864
    s_mul_i32 s32, s30, 1536
    s_add_u32 s31, s31, s32
    s_mul_i32 s32, s30, 884736
    s_lshl_b32 s34, s29, 7
    s_add_u32 s32, s32, s34
    s_add_u32 s32, s32, s37
    v_lshrrev_b32 v4, 3, v1
    v_bfe_u32 v5, v1, 1, 2
    v_and_b32 v6, 1, v1
    v_mul_u32_u24 v5, 9216, v5
    v_lshl_add_u32 v5, v4, 5, v5
    v_lshl_add_u32 v5, v6, 4, v5
    v_and_b32 v6, 7, v1
    v_mul_u32_u24 v4, 18432, v4
    v_lshl_add_u32 v4, v6, 4, v4
    v_lshlrev_b32 v6, 4, v1
    s_waitcnt lgkmcnt(0)
    s_mov_b32 s16, s6
    s_and_b32 s17, s7, 0xffff
    s_mov_b32 s18, 0x2000000
    s_mov_b32 s19, 0x00020000
    s_mov_b32 s20, s8
    s_and_b32 s21, s9, 0xffff
    s_mov_b32 s22, 0x510000
    s_mov_b32 s23, 0x00020000
    s_mov_b32 s24, s10
    s_and_b32 s25, s11, 0xffff
    s_mov_b32 s26, 0x510000
    s_mov_b32 s27, 0x00020000
    s_mov_b32 s12, s4
    s_and_b32 s13, s5, 0xffff
    s_mov_b32 s14, 0x510000
    s_mov_b32 s15, 0x00020000
    s_sleep 6
    buffer_load_dwordx4 v[8:11], v5, s[24:27], s31 offen offset:0
    buffer_load_dwordx4 v[12:15], v5, s[24:27], s31 offen offset:256
    buffer_load_dwordx4 v[16:19], v5, s[24:27], s31 offen offset:512
    buffer_load_dwordx4 v[20:23], v5, s[24:27], s31 offen offset:768
    buffer_load_dwordx4 v[24:27], v5, s[24:27], s31 offen offset:1024
    buffer_load_dwordx4 v[28:31], v5, s[24:27], s31 offen offset:1280
    s_waitcnt vmcnt(0)
    s_add_u32 s35, s32, 0x1400000
    buffer_store_dwordx4 v[8:11], v4, s[16:19], s35 offen sc0 sc1
    s_add_u32 s35, s32, 0x1424000
    buffer_store_dwordx4 v[12:15], v4, s[16:19], s35 offen sc0 sc1
    s_add_u32 s35, s32, 0x1448000
    buffer_store_dwordx4 v[16:19], v4, s[16:19], s35 offen sc0 sc1
    s_add_u32 s35, s32, 0x146c000
    buffer_store_dwordx4 v[20:23], v4, s[16:19], s35 offen sc0 sc1
    s_add_u32 s35, s32, 0x1490000
    buffer_store_dwordx4 v[24:27], v4, s[16:19], s35 offen sc0 sc1
    s_add_u32 s35, s32, 0x14b4000
    buffer_store_dwordx4 v[28:31], v4, s[16:19], s35 offen sc0 sc1
    s_waitcnt vmcnt(0)
K3_END:
    s_endpgm
.text
.globl moe_ffn_kernel
.p2align 8
.type moe_ffn_kernel,@function
moe_ffn_kernel:
    s_load_dwordx4 s[8:11], s[0:1], 40
    s_load_dwordx2 s[4:5], s[0:1], 56
    s_load_dwordx2 s[6:7], s[0:1], 80
    v_and_b32 v1, 63, v0
    v_lshrrev_b32 v3, 6, v0
    s_cmp_ge_u32 s2, 288
    s_cbranch_scc1 K4_END
    v_readfirstlane_b32 s3, v3
    s_and_b32 s28, s2, 7
    s_mul_i32 s28, s28, 36
    s_lshr_b32 s29, s2, 3
    s_add_u32 s28, s28, s29
    v_lshlrev_b32 v2, 4, v1
    s_waitcnt lgkmcnt(0)
    s_mov_b32 s16, s6
    s_and_b32 s17, s7, 0xffff
    s_mov_b32 s18, 0x2000000
    s_mov_b32 s19, 0x00020000
    s_mov_b32 s20, s8
    s_and_b32 s21, s9, 0xffff
    s_mov_b32 s22, 0x510000
    s_mov_b32 s23, 0x00020000
    s_mov_b32 s24, s10
    s_and_b32 s25, s11, 0xffff
    s_mov_b32 s26, 0x510000
    s_mov_b32 s27, 0x00020000
    s_mov_b32 s12, s4
    s_and_b32 s13, s5, 0xffff
    s_mov_b32 s14, 0x510000
    s_mov_b32 s15, 0x00020000
    s_mov_b32 s30, 0x901000
    s_mov_b32 s31, 0x902000
    buffer_load_dwordx4 v[20:23], v2, s[16:19], s30 offen offset:0
    buffer_load_dwordx4 v[24:27], v2, s[16:19], s30 offen offset:1024
    s_mul_i32 s32, s3, 3072
    s_mul_i32 s34, s3, 9216
    s_mul_i32 s35, s28, 18432
    s_add_u32 s32, s32, s35
    s_mul_i32 s33, s3, 192
    s_add_u32 s35, s35, s33
    s_mov_b32 s36, 43691
    v_lshrrev_b32 v3, 1, v1
    v_mul_u32_u24 v3, 9216, v3
    v_and_b32 v4, 1, v1
    v_lshl_add_u32 v3, v4, 4, v3
    s_mul_i32 s37, s3, 884736
    s_lshl_b32 s33, s28, 5
    s_add_u32 s37, s37, s33
    s_add_u32 m0, s34, 0
    s_add_u32 s33, s32, 0x1400000
    buffer_load_dwordx4 v2, s[16:19], s33 offen lds
    s_add_u32 m0, s34, 3072
    s_add_u32 s33, s32, 0x1a00000
    buffer_load_dwordx4 v2, s[16:19], s33 offen lds
    s_add_u32 m0, s34, 1024
    s_add_u32 s33, s32, 0x1400400
    buffer_load_dwordx4 v2, s[16:19], s33 offen lds
    s_add_u32 m0, s34, 4096
    s_add_u32 s33, s32, 0x1a00400
    buffer_load_dwordx4 v2, s[16:19], s33 offen lds
    s_add_u32 m0, s34, 2048
    s_add_u32 s33, s32, 0x1400800
    buffer_load_dwordx4 v2, s[16:19], s33 offen lds
    s_add_u32 m0, s34, 5120
    s_add_u32 s33, s32, 0x1a00800
    buffer_load_dwordx4 v2, s[16:19], s33 offen lds
    v_add_u32 v4, 0, v1
    v_mul_lo_u32 v5, v4, s36
    v_lshrrev_b32 v5, 19, v5
    v_mul_u32_u24 v6, 12, v5
    v_sub_u32 v4, v4, v6
    v_mul_u32_u24 v5, 1152, v5
    v_lshl_add_u32 v4, v4, 4, v5
    s_add_u32 m0, s34, 6144
    s_nop 0
    buffer_load_dwordx4 v4, s[12:15], s35 offen lds
    v_add_u32 v4, 64, v1
    v_mul_lo_u32 v5, v4, s36
    v_lshrrev_b32 v5, 19, v5
    v_mul_u32_u24 v6, 12, v5
    v_sub_u32 v4, v4, v6
    v_mul_u32_u24 v5, 1152, v5
    v_lshl_add_u32 v4, v4, 4, v5
    s_add_u32 m0, s34, 7168
    s_nop 0
    buffer_load_dwordx4 v4, s[12:15], s35 offen lds
    v_add_u32 v4, 128, v1
    v_mul_lo_u32 v5, v4, s36
    v_lshrrev_b32 v5, 19, v5
    v_mul_u32_u24 v6, 12, v5
    v_sub_u32 v4, v4, v6
    v_mul_u32_u24 v5, 1152, v5
    v_lshl_add_u32 v4, v4, 4, v5
    s_add_u32 m0, s34, 8192
    s_nop 0
    buffer_load_dwordx4 v4, s[12:15], s35 offen lds
    v_lshrrev_b32 v13, 4, v1
    v_and_b32 v14, 15, v1
    v_bfe_u32 v5, v1, 2, 2
    v_and_b32 v6, 3, v1
    v_lshl_add_u32 v7, v13, 3, v5
    v_lshlrev_b32 v7, 5, v7
    v_lshl_add_u32 v7, v6, 3, v7
    v_add_u32 v7, s34, v7
    v_lshl_add_u32 v8, v13, 2, v5
    v_mul_u32_u24 v8, 192, v8
    v_lshl_add_u32 v8, v6, 3, v8
    v_add_u32 v8, s34, v8
    s_waitcnt vmcnt(9)
    v_max_u32 v10, v20, v21
    v_min_u32 v11, v20, v21
    v_med3_u32 v11, v10, v11, v22
    v_max_u32 v10, v10, v22
    v_med3_u32 v11, v10, v11, v23
    v_max_u32 v10, v10, v23
    v_med3_u32 v11, v10, v11, v24
    v_max_u32 v10, v10, v24
    v_med3_u32 v11, v10, v11, v25
    v_max_u32 v10, v10, v25
    v_med3_u32 v11, v10, v11, v26
    v_max_u32 v10, v10, v26
    v_med3_u32 v11, v10, v11, v27
    v_max_u32 v10, v10, v27
    s_nop 1
    v_mov_b32_dpp v15, v10 quad_perm:[1,0,3,2] row_mask:0xf bank_mask:0xf
    v_mov_b32_dpp v16, v11 quad_perm:[1,0,3,2] row_mask:0xf bank_mask:0xf
    v_min_u32 v17, v10, v15
    v_max_u32 v10, v10, v15
    v_max3_u32 v11, v11, v16, v17
    s_nop 1
    v_mov_b32_dpp v15, v10 quad_perm:[2,3,0,1] row_mask:0xf bank_mask:0xf
    v_mov_b32_dpp v16, v11 quad_perm:[2,3,0,1] row_mask:0xf bank_mask:0xf
    v_min_u32 v17, v10, v15
    v_max_u32 v10, v10, v15
    v_max3_u32 v11, v11, v16, v17
    s_nop 1
    v_mov_b32_dpp v15, v10 row_half_mirror row_mask:0xf bank_mask:0xf
    v_mov_b32_dpp v16, v11 row_half_mirror row_mask:0xf bank_mask:0xf
    v_min_u32 v17, v10, v15
    v_max_u32 v10, v10, v15
    v_max3_u32 v11, v11, v16, v17
    s_nop 1
    v_mov_b32_dpp v15, v10 row_mirror row_mask:0xf bank_mask:0xf
    v_mov_b32_dpp v16, v11 row_mirror row_mask:0xf bank_mask:0xf
    v_min_u32 v17, v10, v15
    v_max_u32 v10, v10, v15
    v_max3_u32 v11, v11, v16, v17
    v_mov_b32 v15, v10
    v_mov_b32 v16, v11
    s_nop 1
    v_permlane16_swap_b32 v10, v15
    v_permlane16_swap_b32 v11, v16
    v_min_u32 v17, v10, v15
    v_max_u32 v10, v10, v15
    v_max3_u32 v11, v11, v16, v17
    v_mov_b32 v15, v10
    v_mov_b32 v16, v11
    s_nop 1
    v_permlane32_swap_b32 v10, v15
    v_permlane32_swap_b32 v11, v16
    v_min_u32 v17, v10, v15
    v_max_u32 v10, v10, v15
    v_max3_u32 v11, v11, v16, v17
    v_and_b32 v4, 1, v1
    v_cmp_eq_u32 vcc, 1, v4
    s_nop 1
    v_cndmask_b32 v15, v10, v11, vcc
    v_and_b32 v15, 0xffff, v15
    v_sub_u32 v15, 0xffff, v15
    v_mul_u32_u24 v15, 1152, v15
    v_lshl_add_u32 v15, v13, 4, v15
    s_mul_i32 s33, s3, 192
    s_add_u32 s33, s33, 0xd00000
    buffer_load_dwordx4 v[20:23], v15, s[16:19], s33 offen offset:0
    buffer_load_dwordx4 v[24:27], v15, s[16:19], s33 offen offset:64
    buffer_load_dwordx4 v[28:31], v15, s[16:19], s33 offen offset:128
    s_or_b32 s33, s2, s3
    s_cmp_lg_u32 s33, 0
    s_cbranch_scc1 K4_NS
    s_mov_b64 exec, 1
    v_mov_b32 v5, 0
    s_mov_b32 s33, 0x903000
    buffer_store_dwordx2 v[10:11], v5, s[16:19], s33 offen
    s_mov_b64 exec, -1
K4_NS:
    s_waitcnt vmcnt(0)
    ds_read_b64_tr_b16 v[32:33], v7 offset:0
    ds_read_b64_tr_b16 v[34:35], v7 offset:128
    ds_read_b64_tr_b16 v[36:37], v7 offset:1024
    ds_read_b64_tr_b16 v[38:39], v7 offset:1152
    ds_read_b64_tr_b16 v[40:41], v7 offset:2048
    ds_read_b64_tr_b16 v[42:43], v7 offset:2176
    ds_read_b64_tr_b16 v[44:45], v7 offset:3072
    ds_read_b64_tr_b16 v[46:47], v7 offset:3200
    ds_read_b64_tr_b16 v[48:49], v7 offset:4096
    ds_read_b64_tr_b16 v[50:51], v7 offset:4224
    ds_read_b64_tr_b16 v[52:53], v7 offset:5120
    ds_read_b64_tr_b16 v[54:55], v7 offset:5248
    ds_read_b64_tr_b16 v[64:65], v8 offset:6144
    ds_read_b64_tr_b16 v[66:67], v8 offset:6176
    ds_read_b64_tr_b16 v[68:69], v8 offset:6208
    ds_read_b64_tr_b16 v[70:71], v8 offset:6240
    ds_read_b64_tr_b16 v[72:73], v8 offset:6272
    ds_read_b64_tr_b16 v[74:75], v8 offset:6304
    s_lshl_b32 s33, s3, 8
    s_add_u32 s33, s33, 55296
    v_lshlrev_b32 v5, 4, v13
    v_lshl_add_u32 v5, v4, 6, v5
    v_add_u32 v6, s33, v5
    v_add_u32 v5, 55296, v5
    s_waitcnt lgkmcnt(6)
    v_mfma_f32_16x16x32_bf16 v[56:59], v[32:35], v[20:23], 0
    v_mfma_f32_16x16x32_bf16 v[56:59], v[36:39], v[24:27], v[56:59]
    v_mfma_f32_16x16x32_bf16 v[56:59], v[40:43], v[28:31], v[56:59]
    v_mfma_f32_16x16x32_bf16 v[60:63], v[44:47], v[20:23], 0
    v_mfma_f32_16x16x32_bf16 v[60:63], v[48:51], v[24:27], v[60:63]
    v_mfma_f32_16x16x32_bf16 v[60:63], v[52:55], v[28:31], v[60:63]
    s_nop 7
    s_mov_b32 exec_lo, 0x30003
    s_mov_b32 exec_hi, 0x30003
    ds_write_b128 v6, v[56:59]
    ds_write_b128 v6, v[60:63] offset:128
    s_mov_b64 exec, -1
    s_waitcnt lgkmcnt(0)
    s_barrier
    ds_read_b128 v[80:83], v5 offset:0
    ds_read_b128 v[84:87], v5 offset:128
    ds_read_b128 v[88:91], v5 offset:256
    ds_read_b128 v[92:95], v5 offset:384
    ds_read_b128 v[96:99], v5 offset:512
    ds_read_b128 v[100:103], v5 offset:640
    ds_read_b128 v[104:107], v5 offset:768
    ds_read_b128 v[108:111], v5 offset:896
    ds_read_b128 v[112:115], v5 offset:1024
    ds_read_b128 v[116:119], v5 offset:1152
    ds_read_b128 v[120:123], v5 offset:1280
    ds_read_b128 v[124:127], v5 offset:1408
    s_waitcnt lgkmcnt(0)
    v_add_f32 v80, v80, v88
    v_add_f32 v81, v81, v89
    v_add_f32 v82, v82, v90
    v_add_f32 v83, v83, v91
    v_add_f32 v84, v84, v92
    v_add_f32 v85, v85, v93
    v_add_f32 v86, v86, v94
    v_add_f32 v87, v87, v95
    v_add_f32 v80, v80, v96
    v_add_f32 v81, v81, v97
    v_add_f32 v82, v82, v98
    v_add_f32 v83, v83, v99
    v_add_f32 v84, v84, v100
    v_add_f32 v85, v85, v101
    v_add_f32 v86, v86, v102
    v_add_f32 v87, v87, v103
    v_add_f32 v80, v80, v104
    v_add_f32 v81, v81, v105
    v_add_f32 v82, v82, v106
    v_add_f32 v83, v83, v107
    v_add_f32 v84, v84, v108
    v_add_f32 v85, v85, v109
    v_add_f32 v86, v86, v110
    v_add_f32 v87, v87, v111
    v_add_f32 v80, v80, v112
    v_add_f32 v81, v81, v113
    v_add_f32 v82, v82, v114
    v_add_f32 v83, v83, v115
    v_add_f32 v84, v84, v116
    v_add_f32 v85, v85, v117
    v_add_f32 v86, v86, v118
    v_add_f32 v87, v87, v119
    v_add_f32 v80, v80, v120
    v_add_f32 v81, v81, v121
    v_add_f32 v82, v82, v122
    v_add_f32 v83, v83, v123
    v_add_f32 v84, v84, v124
    v_add_f32 v85, v85, v125
    v_add_f32 v86, v86, v126
    v_add_f32 v87, v87, v127
    v_cvt_pk_bf16_f32 v20, v80, v81
    v_cvt_pk_bf16_f32 v21, v82, v83
    v_cvt_pk_bf16_f32 v22, v84, v85
    v_cvt_pk_bf16_f32 v23, v86, v87
    v_lshlrev_b32 v80, 16, v20
    v_and_b32 v81, 0xffff0000, v20
    v_lshlrev_b32 v82, 16, v21
    v_and_b32 v83, 0xffff0000, v21
    v_lshlrev_b32 v84, 16, v22
    v_and_b32 v85, 0xffff0000, v22
    v_lshlrev_b32 v86, 16, v23
    v_and_b32 v87, 0xffff0000, v23
    v_mul_f32 v20, 0xbfb8aa3b, v80
    v_mul_f32 v21, 0xbfb8aa3b, v81
    v_mul_f32 v22, 0xbfb8aa3b, v82
    v_mul_f32 v23, 0xbfb8aa3b, v83
    v_exp_f32 v20, v20
    v_exp_f32 v21, v21
    v_exp_f32 v22, v22
    v_exp_f32 v23, v23
    v_add_f32 v20, 1.0, v20
    v_add_f32 v21, 1.0, v21
    v_add_f32 v22, 1.0, v22
    v_add_f32 v23, 1.0, v23
    v_rcp_f32 v20, v20
    v_rcp_f32 v21, v21
    v_rcp_f32 v22, v22
    v_rcp_f32 v23, v23
    v_mul_f32 v20, v80, v20
    v_mul_f32 v21, v81, v21
    v_mul_f32 v22, v82, v22
    v_mul_f32 v23, v83, v23
    v_cvt_pk_bf16_f32 v24, v20, v21
    v_cvt_pk_bf16_f32 v25, v22, v23
    v_lshlrev_b32 v20, 16, v24
    v_and_b32 v21, 0xffff0000, v24
    v_lshlrev_b32 v22, 16, v25
    v_and_b32 v23, 0xffff0000, v25
    v_mul_f32 v20, v20, v84
    v_mul_f32 v21, v21, v85
    v_mul_f32 v22, v22, v86
    v_mul_f32 v23, v23, v87
    v_cvt_pk_bf16_f32 v24, v20, v21
    v_cvt_pk_bf16_f32 v25, v22, v23
    s_mul_i32 s33, s28, 4608
    s_mul_i32 s34, s3, 384
    s_add_u32 s33, s33, s34
    s_add_u32 s33, s33, 0x1000000
    v_mul_u32_u24 v5, 2304, v14
    v_lshl_add_u32 v5, v13, 4, v5
    v_mfma_f32_16x16x16_bf16 v[32:35], v[64:65], v[24:25], 0
    v_mfma_f32_16x16x16_bf16 v[36:39], v[66:67], v[24:25], 0
    v_mfma_f32_16x16x16_bf16 v[40:43], v[68:69], v[24:25], 0
    v_mfma_f32_16x16x16_bf16 v[44:47], v[70:71], v[24:25], 0
    v_mfma_f32_16x16x16_bf16 v[48:51], v[72:73], v[24:25], 0
    v_mfma_f32_16x16x16_bf16 v[52:55], v[74:75], v[24:25], 0
    s_nop 7
    s_mov_b32 exec_lo, 0x30003
    s_mov_b32 exec_hi, 0x30003
    buffer_store_dwordx4 v[32:35], v5, s[16:19], s33 offen offset:0
    buffer_store_dwordx4 v[36:39], v5, s[16:19], s33 offen offset:64
    buffer_store_dwordx4 v[40:43], v5, s[16:19], s33 offen offset:128
    buffer_store_dwordx4 v[44:47], v5, s[16:19], s33 offen offset:192
    buffer_store_dwordx4 v[48:51], v5, s[16:19], s33 offen offset:256
    buffer_store_dwordx4 v[52:55], v5, s[16:19], s33 offen offset:320
K4_END:
    s_endpgm
.text
.globl moe_fin_kernel
.p2align 8
.type moe_fin_kernel,@function
moe_fin_kernel:
    s_mov_b32 s3, 0
    s_load_dwordx2 s[10:11], s[0:1], 64
    s_load_dwordx2 s[6:7], s[0:1], 80
    s_cmp_ge_u32 s2, 36
    s_cbranch_scc1 K5_END
    v_and_b32 v1, 31, v0
    v_lshrrev_b32 v2, 5, v0
    v_mul_u32_u24 v3, 165888, v2
    v_lshl_add_u32 v3, v1, 2, v3
    s_lshl_b32 s28, s2, 7
    s_waitcnt lgkmcnt(0)
    s_add_u32 s4, s6, 0x903000
    s_addc_u32 s5, s7, 0
    s_load_dwordx2 s[8:9], s[4:5], 0
    s_mov_b32 s16, s6
    s_and_b32 s17, s7, 0xffff
    s_mov_b32 s18, 0x2000000
    s_mov_b32 s19, 0x00020000
    s_mov_b32 s24, s10
    s_and_b32 s25, s11, 0xffff
    s_mov_b32 s26, 0x240000
    s_mov_b32 s27, 0x00020000
    s_add_u32 s28, s28, 0x1000000
    buffer_load_dword v8, v3, s[16:19], s28 offen
    s_add_u32 s28, s28, 4608
    buffer_load_dword v9, v3, s[16:19], s28 offen
    s_add_u32 s28, s28, 4608
    buffer_load_dword v10, v3, s[16:19], s28 offen
    s_add_u32 s28, s28, 4608
    buffer_load_dword v11, v3, s[16:19], s28 offen
    s_add_u32 s28, s28, 4608
    buffer_load_dword v12, v3, s[16:19], s28 offen
    s_add_u32 s28, s28, 4608
    buffer_load_dword v13, v3, s[16:19], s28 offen
    s_add_u32 s28, s28, 4608
    buffer_load_dword v14, v3, s[16:19], s28 offen
    s_add_u32 s28, s28, 4608
    buffer_load_dword v15, v3, s[16:19], s28 offen
    s_add_u32 s28, s28, 4608
    buffer_load_dword v16, v3, s[16:19], s28 offen
    s_add_u32 s28, s28, 4608
    buffer_load_dword v17, v3, s[16:19], s28 offen
    s_add_u32 s28, s28, 4608
    buffer_load_dword v18, v3, s[16:19], s28 offen
    s_add_u32 s28, s28, 4608
    buffer_load_dword v19, v3, s[16:19], s28 offen
    s_add_u32 s28, s28, 4608
    buffer_load_dword v20, v3, s[16:19], s28 offen
    s_add_u32 s28, s28, 4608
    buffer_load_dword v21, v3, s[16:19], s28 offen
    s_add_u32 s28, s28, 4608
    buffer_load_dword v22, v3, s[16:19], s28 offen
    s_add_u32 s28, s28, 4608
    buffer_load_dword v23, v3, s[16:19], s28 offen
    s_add_u32 s28, s28, 4608
    buffer_load_dword v24, v3, s[16:19], s28 offen
    s_add_u32 s28, s28, 4608
    buffer_load_dword v25, v3, s[16:19], s28 offen
    s_add_u32 s28, s28, 4608
    buffer_load_dword v26, v3, s[16:19], s28 offen
    s_add_u32 s28, s28, 4608
    buffer_load_dword v27, v3, s[16:19], s28 offen
    s_add_u32 s28, s28, 4608
    buffer_load_dword v28, v3, s[16:19], s28 offen
    s_add_u32 s28, s28, 4608
    buffer_load_dword v29, v3, s[16:19], s28 offen
    s_add_u32 s28, s28, 4608
    buffer_load_dword v30, v3, s[16:19], s28 offen
    s_add_u32 s28, s28, 4608
    buffer_load_dword v31, v3, s[16:19], s28 offen
    s_add_u32 s28, s28, 4608
    buffer_load_dword v32, v3, s[16:19], s28 offen
    s_add_u32 s28, s28, 4608
    buffer_load_dword v33, v3, s[16:19], s28 offen
    s_add_u32 s28, s28, 4608
    buffer_load_dword v34, v3, s[16:19], s28 offen
    s_add_u32 s28, s28, 4608
    buffer_load_dword v35, v3, s[16:19], s28 offen
    s_add_u32 s28, s28, 4608
    buffer_load_dword v36, v3, s[16:19], s28 offen
    s_add_u32 s28, s28, 4608
    buffer_load_dword v37, v3, s[16:19], s28 offen
    s_add_u32 s28, s28, 4608
    buffer_load_dword v38, v3, s[16:19], s28 offen
    s_add_u32 s28, s28, 4608
    buffer_load_dword v39, v3, s[16:19], s28 offen
    s_add_u32 s28, s28, 4608
    buffer_load_dword v40, v3, s[16:19], s28 offen
    s_add_u32 s28, s28, 4608
    buffer_load_dword v41, v3, s[16:19], s28 offen
    s_add_u32 s28, s28, 4608
    buffer_load_dword v42, v3, s[16:19], s28 offen
    s_add_u32 s28, s28, 4608
    buffer_load_dword v43, v3, s[16:19], s28 offen
    s_add_u32 s28, s28, 4608
    s_waitcnt lgkmcnt(0)
    s_cmp_ge_u32 s2, 18
    s_cselect_b32 s8, s9, s8
    s_cselect_b32 s29, 18, 0
    s_sub_u32 s29, s2, s29
    s_and_b32 s30, s8, 0xffff
    s_sub_u32 s30, 0xffff, s30
    s_mul_i32 s30, s30, 1152
    s_lshl_b32 s29, s29, 6
    s_add_u32 s30, s30, s29
    v_lshlrev_b32 v4, 1, v1
    s_add_u32 s31, s30, 0xa00000
    s_add_u32 s32, s30, 0xd00000
    buffer_load_ushort v5, v4, s[16:19], s31 offen
    buffer_load_ushort v6, v4, s[16:19], s32 offen
    s_and_b32 s33, s8, 0xffff0000
    s_ashr_i32 s34, s33, 31
    s_not_b32 s34, s34
    s_or_b32 s34, s34, 0x80000000
    s_xor_b32 s33, s33, s34
    s_and_b32 s33, s33, 0xffff0000
    v_mov_b32 v7, s33
    v_mul_f32 v7, 0xbfb8aa3b, v7
    v_exp_f32 v7, v7
    s_nop 0
    v_add_f32 v7, 1.0, v7
    v_rcp_f32 v7, v7
    s_nop 0
    v_cvt_pk_bf16_f32 v50, v7, v7
    v_lshlrev_b32 v7, 16, v50
    v_lshlrev_b32 v51, 2, v0
    s_waitcnt vmcnt(2)
    v_add_f32 v8, v8, v9
    v_add_f32 v8, v8, v10
    v_add_f32 v8, v8, v11
    v_add_f32 v8, v8, v12
    v_add_f32 v8, v8, v13
    v_add_f32 v8, v8, v14
    v_add_f32 v8, v8, v15
    v_add_f32 v8, v8, v16
    v_add_f32 v8, v8, v17
    v_add_f32 v8, v8, v18
    v_add_f32 v8, v8, v19
    v_add_f32 v8, v8, v20
    v_add_f32 v8, v8, v21
    v_add_f32 v8, v8, v22
    v_add_f32 v8, v8, v23
    v_add_f32 v8, v8, v24
    v_add_f32 v8, v8, v25
    v_add_f32 v8, v8, v26
    v_add_f32 v8, v8, v27
    v_add_f32 v8, v8, v28
    v_add_f32 v8, v8, v29
    v_add_f32 v8, v8, v30
    v_add_f32 v8, v8, v31
    v_add_f32 v8, v8, v32
    v_add_f32 v8, v8, v33
    v_add_f32 v8, v8, v34
    v_add_f32 v8, v8, v35
    v_add_f32 v8, v8, v36
    v_add_f32 v8, v8, v37
    v_add_f32 v8, v8, v38
    v_add_f32 v8, v8, v39
    v_add_f32 v8, v8, v40
    v_add_f32 v8, v8, v41
    v_add_f32 v8, v8, v42
    v_add_f32 v8, v8, v43
    ds_write_b32 v51, v8
    s_waitcnt lgkmcnt(0)
    s_barrier
    v_cmp_gt_u32 vcc, 32, v0
    s_and_saveexec_b64 s[34:35], vcc
    s_cbranch_execz K5_END
    ds_read2_b32 v[8:9], v51 offset0:0 offset1:32
    ds_read2_b32 v[10:11], v51 offset0:64 offset1:96
    ds_read2_b32 v[12:13], v51 offset0:128 offset1:160
    ds_read2_b32 v[14:15], v51 offset0:192 offset1:224
    s_waitcnt lgkmcnt(0)
    v_add_f32 v8, v8, v9
    v_add_f32 v8, v8, v10
    v_add_f32 v8, v8, v11
    v_add_f32 v8, v8, v12
    v_add_f32 v8, v8, v13
    v_add_f32 v8, v8, v14
    v_add_f32 v8, v8, v15
    v_cvt_pk_bf16_f32 v50, v8, v8
    v_lshlrev_b32 v8, 16, v50
    v_mul_f32 v8, v8, v7
    v_cvt_pk_bf16_f32 v50, v8, v8
    v_lshlrev_b32 v8, 16, v50
    s_waitcnt vmcnt(0)
    v_lshlrev_b32 v5, 16, v5
    v_lshlrev_b32 v6, 16, v6
    v_add_f32 v8, v6, v8
    v_cvt_pk_bf16_f32 v50, v8, v8
    v_lshlrev_b32 v8, 16, v50
    v_add_f32 v8, v5, v8
    v_cvt_pk_bf16_f32 v8, v8, v8
    buffer_store_short v8, v4, s[24:27], s30 offen sc0 sc1
K5_END:
    s_endpgm
.section .rodata,"a"
.p2align 6
.amdhsa_kernel fft_rows_kernel
  .amdhsa_next_free_vgpr 128
  .amdhsa_next_free_sgpr 72
  .amdhsa_accum_offset 128
  .amdhsa_group_segment_fixed_size 0
  .amdhsa_kernarg_size 88
  .amdhsa_user_sgpr_count 2
  .amdhsa_user_sgpr_kernarg_segment_ptr 1
  .amdhsa_system_sgpr_workgroup_id_x 1
.end_amdhsa_kernel
.section .rodata,"a"
.p2align 6
.amdhsa_kernel fft_cols_kernel
  .amdhsa_next_free_vgpr 176
  .amdhsa_next_free_sgpr 72
  .amdhsa_accum_offset 176
  .amdhsa_group_segment_fixed_size 0
  .amdhsa_kernarg_size 88
  .amdhsa_user_sgpr_count 2
  .amdhsa_user_sgpr_kernarg_segment_ptr 1
  .amdhsa_system_sgpr_workgroup_id_x 1
.end_amdhsa_kernel
.section .rodata,"a"
.p2align 6
.amdhsa_kernel ifft_rows_kernel
  .amdhsa_next_free_vgpr 148
  .amdhsa_next_free_sgpr 72
  .amdhsa_accum_offset 148
  .amdhsa_group_segment_fixed_size 0
  .amdhsa_kernarg_size 88
  .amdhsa_user_sgpr_count 2
  .amdhsa_user_sgpr_kernarg_segment_ptr 1
  .amdhsa_system_sgpr_workgroup_id_x 1
.end_amdhsa_kernel
.section .rodata,"a"
.p2align 6
.amdhsa_kernel moe_ffn_kernel
  .amdhsa_next_free_vgpr 128
  .amdhsa_next_free_sgpr 72
  .amdhsa_accum_offset 128
  .amdhsa_group_segment_fixed_size 0
  .amdhsa_kernarg_size 88
  .amdhsa_user_sgpr_count 2
  .amdhsa_user_sgpr_kernarg_segment_ptr 1
  .amdhsa_system_sgpr_workgroup_id_x 1
.end_amdhsa_kernel
.section .rodata,"a"
.p2align 6
.amdhsa_kernel moe_fin_kernel
  .amdhsa_next_free_vgpr 56
  .amdhsa_next_free_sgpr 72
  .amdhsa_accum_offset 56
  .amdhsa_group_segment_fixed_size 0
  .amdhsa_kernarg_size 88
  .amdhsa_user_sgpr_count 2
  .amdhsa_user_sgpr_kernarg_segment_ptr 1
  .amdhsa_system_sgpr_workgroup_id_x 1
.end_amdhsa_kernel
```
